```python
import torch

def _softmax(x, axis=-1):
    return torch.softmax(x, dim=axis)
def _gelu(x):
    return torch.nn.functional.gelu(x, approximate="tanh")
def _silu(x):
    return torch.nn.functional.silu(x)
def _sigmoid(x):
    return torch.sigmoid(x)
def _layernorm(x, axis=-1, eps=1e-5):
    m = x.mean(dim=axis, keepdim=True)
    v = x.var(dim=axis, keepdim=True, unbiased=False)
    return (x - m) / torch.sqrt(v + eps)
def _scatter_add(tgt, idx, src, axis=0):
    return tgt.clone().index_add_(axis, idx, src)
def _segment_sum(src, seg, n):
    out = torch.zeros((n,) + src.shape[1:], dtype=src.dtype)
    return out.index_add_(0, seg, src)
def _pad(x, pw):
    flat = tuple(v for pair in reversed(pw) for v in pair)
    return torch.nn.functional.pad(x, flat)

kernel_name = 'standalone__mha_block_cached__decode'

def setup_inputs():

    _w = (lambda a: (lambda t: t.to(torch.bfloat16) if t.is_floating_point() else t)(torch.as_tensor(a)))
    B, Sq, D = 2, 1, 640
    H, Sk, Dh = 32, 16384, 128
    return {
        "x": _w((lambda *s: torch.randn(*s, dtype=torch.bfloat16) * 0.8)(B, Sq, D)),
        "k_cache": _w((lambda *s: torch.randn(*s, dtype=torch.bfloat16) * 0.8)(B, H, Sk, Dh)),
        "v_cache": _w((lambda *s: torch.randn(*s, dtype=torch.bfloat16) * 0.05)(B, H, Sk, Dh)),
        "wq": _w((lambda *s: torch.randn(*s, dtype=torch.bfloat16) * 0.8)(D, H * Dh) * (D ** -0.5)),
        "wo": _w((lambda *s: torch.randn(*s, dtype=torch.bfloat16) * 0.05)(H * Dh, D) * ((H * Dh) ** -0.5)),
    }

def reference(x, k_cache, v_cache, wq, wo):
    B, Sq, D = x.shape
    H, Dh = 32, 128
    q = (lambda x, *d: x.permute(*d))((x @ wq).reshape(B, Sq, H, Dh), 0, 2, 1, 3)
    scores = torch.einsum("bhqd,bhkd->bhqk", q, k_cache) * (Dh ** -0.5)
    p = _softmax(scores, axis=-1)
    o = torch.einsum("bhqk,bhkd->bhqd", p, v_cache)
    return (lambda x, *d: x.permute(*d))(o, 0, 2, 1, 3).reshape(B, Sq, H * Dh) @ wo
```

```asm
; @launch grid=(256,1,1) block=(384,1,1) lds=69632
.amdgcn_target "amdgcn-amd-amdhsa--gfx950"
.text
.globl standalone__mha_block_cached__decode_kernel
.p2align 8
.type standalone__mha_block_cached__decode_kernel,@function
standalone__mha_block_cached__decode_kernel:
s_load_dwordx16 s[4:19], s[0:1], 0
s_cmp_ge_u32 s2, 256
s_cbranch_scc1 L_end
v_lshrrev_b32 v1, 6, v0
v_and_b32 v0, 63, v0
v_readfirstlane_b32 s3, v1
s_lshr_b32 s33, s2, 3
s_and_b32 s34, s2, 7
s_lshr_b32 s29, s33, 3
s_lshl1_add_u32 s29, s29, s33
s_sub_u32 s39, s34, s29
s_and_b32 s39, s39, 7
v_and_b32 v2, 15, v0
v_lshrrev_b32 v3, 4, v0
s_cmp_ge_u32 s3, 4
s_cbranch_scc1 L_service
v_and_b32 v54, 3, v0
v_lshlrev_b32 v54, 4, v54
v_lshl_add_u32 v54, v3, 6, v54
s_mov_b32 s28, 0
s_bitcmp1_b32 s3, 0
s_cselect_b32 s29, 0x200, 0
s_xor_b32 s28, s28, s29
s_bitcmp1_b32 s3, 1
s_cselect_b32 s29, 0x11400, 0
s_xor_b32 s28, s28, s29
s_bitcmp1_b32 s34, 0
s_cselect_b32 s29, 0x2000, 0
s_xor_b32 s28, s28, s29
s_bitcmp1_b32 s34, 1
s_cselect_b32 s29, 0x40100, 0
s_xor_b32 s28, s28, s29
s_bitcmp1_b32 s34, 2
s_cselect_b32 s29, 0x800, 0
s_xor_b32 s28, s28, s29
s_bitcmp1_b32 s33, 2
s_cselect_b32 s29, 0x3000, 0
s_xor_b32 s28, s28, s29
v_bfe_i32 v1, v0, 2, 1
v_and_b32 v1, 0x9000, v1
v_xor_b32 v8, v1, v54
v_bfe_i32 v1, v0, 3, 1
v_and_b32 v1, 0x200000, v1
v_xor_b32 v8, v1, v8
v_xor_b32 v4, s28, v8
v_xor_b32 v5, 0x1000, v4
v_xor_b32 v6, 0x100, v4
v_xor_b32 v7, 0x1100, v4
s_lshl_b32 s29, s33, 22
s_mov_b32 s22, 0x8400000
s_mov_b32 s23, 0x20000
s_cmp_ge_u32 s39, 4
s_cselect_b64 vcc, -1, 0
s_cbranch_scc1 L_prq
s_waitcnt lgkmcnt(0)
s_add_u32 s20, s6, s29
s_addc_u32 s21, s7, 0
buffer_load_dwordx4 v[128:131], v4, s[20:23], 0 offen nt
buffer_load_dwordx4 v[132:135], v5, s[20:23], 0 offen nt
buffer_load_dwordx4 v[136:139], v6, s[20:23], 0 offen nt
buffer_load_dwordx4 v[140:143], v7, s[20:23], 0 offen nt
v_xor_b32 v4, 0x10200, v4
buffer_load_dwordx4 v[144:147], v4, s[20:23], 0 offen nt
s_branch L_first
L_prq:
v_lshrrev_b32 v1, 3, v0
v_and_b32 v9, 7, v0
v_lshlrev_b32 v9, 4, v9
v_lshl_add_u32 v1, v1, 13, v9
s_and_b32 s30, s39, 1
s_lshl2_add_u32 s30, s30, s3
s_mulk_i32 s30, 0x1400
s_bfe_u32 s31, s39, 0x10001
s_add_u32 s30, s30, s31
s_lshl1_add_u32 s30, s33, s30
s_lshl_b32 s30, s30, 7
s_mul_i32 s31, s3, 0x2800
s_add_u32 m0, s31, 24576
s_mov_b32 s26, 0x500000
s_mov_b32 s27, s23
s_mov_b32 s35, 9
s_waitcnt lgkmcnt(0)
s_mov_b64 s[24:25], s[10:11]
L_pre:
s_waitcnt vmcnt(6)
buffer_load_dwordx4 v1, s[24:27], s30 offen nt lds
s_addk_i32 m0, 0x400
s_add_u32 s30, s30, 0x10000
s_sub_u32 s35, s35, 1
s_cbranch_scc0 L_pre
s_add_u32 s20, s6, s29
s_addc_u32 s21, s7, 0
s_waitcnt vmcnt(5)
buffer_load_dwordx4 v[128:131], v4, s[20:23], 0 offen nt
s_waitcnt vmcnt(5)
buffer_load_dwordx4 v[132:135], v5, s[20:23], 0 offen nt
s_waitcnt vmcnt(5)
buffer_load_dwordx4 v[136:139], v6, s[20:23], 0 offen nt
s_waitcnt vmcnt(5)
buffer_load_dwordx4 v[140:143], v7, s[20:23], 0 offen nt
v_xor_b32 v4, 0x10200, v4
s_waitcnt vmcnt(5)
buffer_load_dwordx4 v[144:147], v4, s[20:23], 0 offen nt
L_first:
v_xor_b32 v5, 0x10200, v5
v_xor_b32 v6, 0x10200, v6
v_xor_b32 v7, 0x10200, v7
v_xor_b32 v4, 0x30700, v4
s_add_u32 s36, s8, s29
s_addc_u32 s37, s9, 0
s_waitcnt vmcnt(5)
s_cbranch_vccnz L_w1
s_waitcnt vmcnt(4)
L_w1:
buffer_load_dwordx4 v[148:151], v5, s[20:23], 0 offen nt
v_xor_b32 v5, 0x30700, v5
s_cbranch_vccz L_noa
s_barrier
L_noa:
s_waitcnt vmcnt(5)
s_cbranch_vccnz L_w2
s_waitcnt vmcnt(4)
L_w2:
buffer_load_dwordx4 v[152:155], v6, s[20:23], 0 offen nt
v_xor_b32 v6, 0x30700, v6
s_waitcnt vmcnt(5)
s_cbranch_vccnz L_w3
s_waitcnt vmcnt(4)
L_w3:
buffer_load_dwordx4 v[156:159], v7, s[20:23], 0 offen nt
v_xor_b32 v7, 0x30700, v7
s_waitcnt vmcnt(5)
s_cbranch_vccnz L_w4
s_waitcnt vmcnt(4)
L_w4:
buffer_load_dwordx4 v[160:163], v4, s[20:23], 0 offen nt
v_xor_b32 v4, 0x10200, v4
s_waitcnt vmcnt(5)
s_cbranch_vccnz L_w5
s_waitcnt vmcnt(4)
L_w5:
buffer_load_dwordx4 v[164:167], v5, s[20:23], 0 offen nt
v_xor_b32 v5, 0x10200, v5
v_bfe_u32 v1, v0, 2, 2
v_cmp_eq_u32 s[48:49], 0, v1
v_cmp_eq_u32 s[50:51], 1, v1
v_cmp_eq_u32 s[52:53], 2, v1
v_cmp_eq_u32 s[54:55], 3, v1
v_and_b32 v1, 1, v0
v_lshlrev_b32 v1, 4, v1
v_mov_b32 v55, 0xffff
v_lshlrev_b32 v55, v1, v55
v_lshrrev_b32 v60, 1, v2
v_add_u32 v54, 4096, v54
s_waitcnt vmcnt(5)
s_cbranch_vccnz L_w6
s_waitcnt vmcnt(4)
L_w6:
buffer_load_dwordx4 v[168:171], v6, s[20:23], 0 offen nt
v_xor_b32 v6, 0x10200, v6
s_waitcnt vmcnt(5)
s_cbranch_vccnz L_w7
s_waitcnt vmcnt(4)
L_w7:
buffer_load_dwordx4 v[172:175], v7, s[20:23], 0 offen nt
v_xor_b32 v7, 0x10200, v7
s_waitcnt vmcnt(5)
s_cbranch_vccnz L_w8
s_waitcnt vmcnt(4)
L_w8:
buffer_load_dwordx4 v[176:179], v4, s[20:23], 0 offen nt
v_xor_b32 v4, 0x130700, v4
s_waitcnt vmcnt(5)
s_cbranch_vccnz L_w9
s_waitcnt vmcnt(4)
L_w9:
buffer_load_dwordx4 v[180:183], v5, s[20:23], 0 offen nt
v_xor_b32 v5, 0x130700, v5
s_waitcnt vmcnt(5)
s_cbranch_vccnz L_w10
s_waitcnt vmcnt(4)
L_w10:
buffer_load_dwordx4 v[184:187], v6, s[20:23], 0 offen nt
v_xor_b32 v6, 0x130700, v6
v_lshlrev_b32 v1, 4, v2
v_xor_b32 v8, v1, v8
v_bfe_i32 v1, v0, 4, 1
v_and_b32 v1, 0x9000, v1
v_xor_b32 v8, v1, v8
v_bfe_i32 v1, v0, 5, 1
v_and_b32 v1, 0x200000, v1
v_xor_b32 v8, v1, v8
s_lshl_b32 s29, s3, 11
s_add_u32 s29, s29, 8192
v_and_b32 v61, 60, v0
v_add_u32 v61, s29, v61
v_lshl_add_u32 v62, v3, 4, s29
s_waitcnt vmcnt(5)
s_cbranch_vccnz L_w11
s_waitcnt vmcnt(4)
L_w11:
buffer_load_dwordx4 v[188:191], v7, s[20:23], 0 offen nt
v_xor_b32 v7, 0x130700, v7
s_waitcnt vmcnt(5)
s_cbranch_vccnz L_w12
s_waitcnt vmcnt(4)
L_w12:
buffer_load_dwordx4 v[192:195], v4, s[20:23], 0 offen nt
v_xor_b32 v4, 0x10200, v4
s_waitcnt vmcnt(5)
s_cbranch_vccnz L_w13
s_waitcnt vmcnt(4)
L_w13:
buffer_load_dwordx4 v[196:199], v5, s[20:23], 0 offen nt
v_xor_b32 v5, 0x10200, v5
s_waitcnt vmcnt(5)
s_cbranch_vccnz L_w14
s_waitcnt vmcnt(4)
L_w14:
buffer_load_dwordx4 v[200:203], v6, s[20:23], 0 offen nt
v_xor_b32 v6, 0x10200, v6
s_waitcnt vmcnt(5)
s_cbranch_vccnz L_w15
s_waitcnt vmcnt(4)
L_w15:
buffer_load_dwordx4 v[204:207], v7, s[20:23], 0 offen nt
v_xor_b32 v7, 0x10200, v7
s_lshl2_add_u32 s29, s3, 5120
v_mov_b32 v9, s29
v_mov_b32 v10, 5152
v_mov_b32 v11, 10
v_mov_b32 v46, 0
s_lshr_b32 s29, s3, 1
s_lshl2_add_u32 s29, s29, 4608
v_lshl_add_u32 v47, v0, 3, s29
v_mov_b32 v32, 0
v_mov_b32 v33, 0
v_mov_b32 v34, 0
v_mov_b32 v35, 0
s_waitcnt vmcnt(5)
s_cbranch_vccnz L_w16
s_waitcnt vmcnt(4)
L_w16:
buffer_load_dwordx4 v[208:211], v4, s[20:23], 0 offen nt
v_xor_b32 v4, 0x30700, v4
s_waitcnt vmcnt(5)
s_cbranch_vccnz L_w17
s_waitcnt vmcnt(4)
L_w17:
buffer_load_dwordx4 v[212:215], v5, s[20:23], 0 offen nt
v_xor_b32 v5, 0x30700, v5
s_waitcnt vmcnt(5)
s_cbranch_vccnz L_w18
s_waitcnt vmcnt(4)
L_w18:
buffer_load_dwordx4 v[216:219], v6, s[20:23], 0 offen nt
v_xor_b32 v6, 0x30700, v6
s_waitcnt vmcnt(5)
s_cbranch_vccnz L_w19
s_waitcnt vmcnt(4)
L_w19:
buffer_load_dwordx4 v[220:223], v7, s[20:23], 0 offen nt
v_xor_b32 v7, 0x30700, v7
s_waitcnt vmcnt(5)
s_cbranch_vccnz L_w20
s_waitcnt vmcnt(4)
L_w20:
buffer_load_dwordx4 v[224:227], v4, s[20:23], 0 offen nt
v_xor_b32 v4, 0x10200, v4
s_lshl_b32 s29, s3, 10
v_lshl_add_u32 v63, v60, 7, s29
v_and_b32 v1, 1, v0
v_lshl_add_u32 v63, v1, 5, v63
v_and_b32 v1, 1, v3
v_lshl_add_u32 v53, v1, 6, v63
v_lshl_add_u32 v63, v1, 4, v63
v_lshrrev_b32 v44, 1, v3
v_lshl_add_u32 v53, v44, 4, v53
v_lshl_add_u32 v63, v44, 6, v63
v_lshl_add_u32 v1, v1, 1, v44
v_mul_u32_u24 v3, 0x500, v1
v_lshl_add_u32 v3, v2, 4, v3
s_waitcnt vmcnt(5)
s_cbranch_vccnz L_w21
s_waitcnt vmcnt(4)
L_w21:
buffer_load_dwordx4 v[228:231], v5, s[20:23], 0 offen nt
v_xor_b32 v5, 0x10200, v5
s_waitcnt vmcnt(5)
s_cbranch_vccnz L_w22
s_waitcnt vmcnt(4)
L_w22:
buffer_load_dwordx4 v[232:235], v6, s[20:23], 0 offen nt
v_xor_b32 v6, 0x10200, v6
s_waitcnt vmcnt(5)
s_cbranch_vccnz L_w23
s_waitcnt vmcnt(4)
L_w23:
buffer_load_dwordx4 v[236:239], v7, s[20:23], 0 offen nt
v_xor_b32 v7, 0x10200, v7
s_waitcnt vmcnt(5)
s_cbranch_vccnz L_w24
s_waitcnt vmcnt(4)
L_w24:
buffer_load_dwordx4 v[240:243], v4, s[20:23], 0 offen nt
v_xor_b32 v4, 0x1b4300, v4
s_waitcnt vmcnt(5)
s_cbranch_vccnz L_w25
s_waitcnt vmcnt(4)
L_w25:
buffer_load_dwordx4 v[244:247], v5, s[20:23], 0 offen nt
v_xor_b32 v5, 0x1b4300, v5
v_bfe_u32 v1, v0, 1, 1
v_lshrrev_b32 v44, 3, v2
v_lshl_add_u32 v1, v44, 1, v1
v_cmp_eq_u32 s[64:65], 0, v1
v_cmp_eq_u32 s[66:67], 1, v1
v_cmp_eq_u32 s[68:69], 2, v1
v_cmp_eq_u32 s[70:71], 3, v1
v_lshrrev_b32 v1, 3, v0
v_lshlrev_b32 v2, 10, v1
v_and_b32 v1, 7, v0
v_lshl_add_u32 v2, v1, 4, v2
s_lshl_b32 s29, s3, 8
v_add_u32 v2, s29, v2
s_waitcnt vmcnt(5)
s_cbranch_vccnz L_w26
s_waitcnt vmcnt(4)
L_w26:
buffer_load_dwordx4 v[248:251], v6, s[20:23], 0 offen nt
v_xor_b32 v6, 0x1b4300, v6
s_waitcnt vmcnt(5)
s_cbranch_vccnz L_w27
s_waitcnt vmcnt(4)
L_w27:
buffer_load_dwordx4 v[252:255], v7, s[20:23], 0 offen nt
v_xor_b32 v7, 0x1b4300, v7
s_waitcnt vmcnt(5)
s_cbranch_vccnz L_w28
s_waitcnt vmcnt(4)
L_w28:
buffer_load_dwordx4 v[64:67], v4, s[20:23], 0 offen nt
v_xor_b32 v4, 0x10200, v4
s_waitcnt vmcnt(5)
s_cbranch_vccnz L_w29
s_waitcnt vmcnt(4)
L_w29:
buffer_load_dwordx4 v[68:71], v5, s[20:23], 0 offen nt
v_xor_b32 v5, 0x10200, v5
s_waitcnt vmcnt(5)
s_cbranch_vccnz L_w30
s_waitcnt vmcnt(4)
L_w30:
buffer_load_dwordx4 v[72:75], v6, s[20:23], 0 offen nt
v_xor_b32 v6, 0x10200, v6
s_lshl2_add_u32 s56, s33, s3
s_mul_i32 s56, s56, 160
s_add_u32 s56, s56, s34
s_lshl_b32 s56, s56, 8
s_mov_b64 s[24:25], s[12:13]
s_cmp_lt_u32 s34, 5
s_cselect_b32 s26, 0x500000, 0
s_mov_b32 s27, 0x20000
s_mul_i32 s29, s33, 80128
s_add_u32 s60, s18, s29
s_addc_u32 s61, s19, 0
s_mov_b32 s62, 8192
s_mov_b32 s63, 0x20000
s_and_b32 s57, s3, 1
s_mul_i32 s57, s57, 12
s_waitcnt vmcnt(5)
s_cbranch_vccnz L_w31
s_waitcnt vmcnt(4)
L_w31:
buffer_load_dwordx4 v[76:79], v7, s[20:23], 0 offen nt
v_xor_b32 v7, 0x10200, v7
s_waitcnt vmcnt(5)
s_cbranch_vccnz L_w32
s_waitcnt vmcnt(4)
L_w32:
buffer_load_dwordx4 v[80:83], v4, s[20:23], 0 offen nt
v_xor_b32 v4, 0x30700, v4
s_waitcnt vmcnt(5)
s_cbranch_vccnz L_w33
s_waitcnt vmcnt(4)
L_w33:
buffer_load_dwordx4 v[84:87], v5, s[20:23], 0 offen nt
v_xor_b32 v5, 0x30700, v5
s_waitcnt vmcnt(5)
s_cbranch_vccnz L_w34
s_waitcnt vmcnt(4)
L_w34:
buffer_load_dwordx4 v[88:91], v6, s[20:23], 0 offen nt
v_xor_b32 v6, 0x30700, v6
s_waitcnt vmcnt(5)
s_cbranch_vccnz L_w35
s_waitcnt vmcnt(4)
L_w35:
buffer_load_dwordx4 v[92:95], v7, s[20:23], 0 offen nt
v_xor_b32 v7, 0x30700, v7
s_waitcnt vmcnt(5)
s_cbranch_vccnz L_w36
s_waitcnt vmcnt(4)
L_w36:
buffer_load_dwordx4 v[96:99], v4, s[20:23], 0 offen nt
v_xor_b32 v4, 0x10200, v4
s_waitcnt vmcnt(5)
s_cbranch_vccnz L_w37
s_waitcnt vmcnt(4)
L_w37:
buffer_load_dwordx4 v[100:103], v5, s[20:23], 0 offen nt
v_xor_b32 v5, 0x10200, v5
s_waitcnt vmcnt(5)
s_cbranch_vccnz L_w38
s_waitcnt vmcnt(4)
L_w38:
buffer_load_dwordx4 v[104:107], v6, s[20:23], 0 offen nt
v_xor_b32 v6, 0x10200, v6
s_waitcnt vmcnt(5)
s_cbranch_vccnz L_w39
s_waitcnt vmcnt(4)
L_w39:
buffer_load_dwordx4 v[108:111], v7, s[20:23], 0 offen nt
v_xor_b32 v7, 0x10200, v7
s_branch L_po0
L_pad0:
s_setpc_b64 s[64:65]
L_po0:
s_barrier
ds_read_b128 v[56:59], v54
ds_read_b128 v[48:51], v54 offset:256
s_waitcnt vmcnt(5)
s_cbranch_vccnz L_w40
s_waitcnt vmcnt(4)
L_w40:
buffer_load_dwordx4 v[112:115], v4, s[20:23], 0 offen nt
v_xor_b32 v4, 0x130700, v4
s_waitcnt lgkmcnt(0)
v_cndmask_b32 v16, 0, v56, s[48:49]
v_cndmask_b32 v17, 0, v57, s[48:49]
v_cndmask_b32 v18, 0, v58, s[48:49]
v_cndmask_b32 v19, 0, v59, s[48:49]
v_cndmask_b32 v20, 0, v56, s[50:51]
v_cndmask_b32 v21, 0, v57, s[50:51]
v_cndmask_b32 v22, 0, v58, s[50:51]
v_cndmask_b32 v23, 0, v59, s[50:51]
v_cndmask_b32 v24, 0, v56, s[52:53]
v_cndmask_b32 v25, 0, v57, s[52:53]
v_cndmask_b32 v26, 0, v58, s[52:53]
v_cndmask_b32 v27, 0, v59, s[52:53]
v_cndmask_b32 v28, 0, v56, s[54:55]
v_cndmask_b32 v29, 0, v57, s[54:55]
v_cndmask_b32 v30, 0, v58, s[54:55]
v_cndmask_b32 v31, 0, v59, s[54:55]
s_waitcnt vmcnt(5)
s_cbranch_vccnz L_w41
s_waitcnt vmcnt(4)
L_w41:
buffer_load_dwordx4 v[116:119], v5, s[20:23], 0 offen nt
v_xor_b32 v5, 0x130700, v5
s_waitcnt vmcnt(6)
v_mfma_f32_16x16x32_bf16 v[36:39], v[64:67], v[16:19], 0
v_mfma_f32_16x16x32_bf16 v[36:39], v[68:71], v[20:23], v[36:39]
v_mfma_f32_16x16x32_bf16 v[36:39], v[72:75], v[24:27], v[36:39]
v_mfma_f32_16x16x32_bf16 v[36:39], v[76:79], v[28:31], v[36:39]
v_mfma_f32_16x16x32_bf16 v[40:43], v[80:83], v[16:19], 0
v_mfma_f32_16x16x32_bf16 v[40:43], v[84:87], v[20:23], v[40:43]
v_mfma_f32_16x16x32_bf16 v[40:43], v[88:91], v[24:27], v[40:43]
v_mfma_f32_16x16x32_bf16 v[40:43], v[92:95], v[28:31], v[40:43]
s_nop 3
v_mov_b32_dpp v44, v36 quad_perm:[0,0,0,0] row_mask:0xf bank_mask:0xf
v_mov_b32_dpp v45, v38 quad_perm:[2,2,2,2] row_mask:0xf bank_mask:0xf
s_nop 0
v_add_f32_dpp v44, v37, v44 quad_perm:[1,1,1,1] row_mask:0xf bank_mask:0xf
v_add_f32_dpp v45, v39, v45 quad_perm:[3,3,3,3] row_mask:0xf bank_mask:0xf
v_add_f32 v44, v44, v45
ds_write_b32 v61, v44 offset:512
v_mov_b32_dpp v44, v40 quad_perm:[0,0,0,0] row_mask:0xf bank_mask:0xf
v_mov_b32_dpp v45, v42 quad_perm:[2,2,2,2] row_mask:0xf bank_mask:0xf
s_nop 0
v_add_f32_dpp v44, v41, v44 quad_perm:[1,1,1,1] row_mask:0xf bank_mask:0xf
v_add_f32_dpp v45, v43, v45 quad_perm:[3,3,3,3] row_mask:0xf bank_mask:0xf
v_add_f32 v44, v44, v45
ds_write_b32 v61, v44 offset:576
s_waitcnt vmcnt(5)
s_cbranch_vccnz L_w42
s_waitcnt vmcnt(4)
L_w42:
buffer_load_dwordx4 v[120:123], v6, s[20:23], 0 offen nt
v_xor_b32 v6, 0x130700, v6
v_mfma_f32_16x16x32_bf16 v[36:39], v[128:131], v[16:19], 0
v_mfma_f32_16x16x32_bf16 v[36:39], v[132:135], v[20:23], v[36:39]
v_mfma_f32_16x16x32_bf16 v[36:39], v[136:139], v[24:27], v[36:39]
v_mfma_f32_16x16x32_bf16 v[36:39], v[140:143], v[28:31], v[36:39]
v_mfma_f32_16x16x32_bf16 v[40:43], v[144:147], v[16:19], 0
v_mfma_f32_16x16x32_bf16 v[40:43], v[148:151], v[20:23], v[40:43]
v_mfma_f32_16x16x32_bf16 v[40:43], v[152:155], v[24:27], v[40:43]
v_mfma_f32_16x16x32_bf16 v[40:43], v[156:159], v[28:31], v[40:43]
s_nop 3
v_mov_b32_dpp v44, v36 quad_perm:[0,0,0,0] row_mask:0xf bank_mask:0xf
v_mov_b32_dpp v45, v38 quad_perm:[2,2,2,2] row_mask:0xf bank_mask:0xf
s_nop 0
v_add_f32_dpp v44, v37, v44 quad_perm:[1,1,1,1] row_mask:0xf bank_mask:0xf
v_add_f32_dpp v45, v39, v45 quad_perm:[3,3,3,3] row_mask:0xf bank_mask:0xf
v_add_f32 v44, v44, v45
ds_write_b32 v61, v44 offset:0
v_mov_b32_dpp v44, v40 quad_perm:[0,0,0,0] row_mask:0xf bank_mask:0xf
v_mov_b32_dpp v45, v42 quad_perm:[2,2,2,2] row_mask:0xf bank_mask:0xf
s_nop 0
v_add_f32_dpp v44, v41, v44 quad_perm:[1,1,1,1] row_mask:0xf bank_mask:0xf
v_add_f32_dpp v45, v43, v45 quad_perm:[3,3,3,3] row_mask:0xf bank_mask:0xf
v_add_f32 v44, v44, v45
ds_write_b32 v61, v44 offset:64
s_branch L_po1
L_pad1:
s_setpc_b64 s[64:65]
L_po1:
s_waitcnt vmcnt(5)
s_cbranch_vccnz L_w43
s_waitcnt vmcnt(4)
L_w43:
buffer_load_dwordx4 v[124:127], v7, s[20:23], 0 offen nt
v_xor_b32 v7, 0x130700, v7
v_mfma_f32_16x16x32_bf16 v[36:39], v[160:163], v[16:19], 0
v_mfma_f32_16x16x32_bf16 v[36:39], v[164:167], v[20:23], v[36:39]
v_mfma_f32_16x16x32_bf16 v[36:39], v[168:171], v[24:27], v[36:39]
v_mfma_f32_16x16x32_bf16 v[36:39], v[172:175], v[28:31], v[36:39]
v_mfma_f32_16x16x32_bf16 v[40:43], v[176:179], v[16:19], 0
v_mfma_f32_16x16x32_bf16 v[40:43], v[180:183], v[20:23], v[40:43]
v_mfma_f32_16x16x32_bf16 v[40:43], v[184:187], v[24:27], v[40:43]
v_mfma_f32_16x16x32_bf16 v[40:43], v[188:191], v[28:31], v[40:43]
s_nop 3
v_mov_b32_dpp v44, v36 quad_perm:[0,0,0,0] row_mask:0xf bank_mask:0xf
v_mov_b32_dpp v45, v38 quad_perm:[2,2,2,2] row_mask:0xf bank_mask:0xf
s_nop 0
v_add_f32_dpp v44, v37, v44 quad_perm:[1,1,1,1] row_mask:0xf bank_mask:0xf
v_add_f32_dpp v45, v39, v45 quad_perm:[3,3,3,3] row_mask:0xf bank_mask:0xf
v_add_f32 v44, v44, v45
ds_write_b32 v61, v44 offset:128
v_mov_b32_dpp v44, v40 quad_perm:[0,0,0,0] row_mask:0xf bank_mask:0xf
v_mov_b32_dpp v45, v42 quad_perm:[2,2,2,2] row_mask:0xf bank_mask:0xf
s_nop 0
v_add_f32_dpp v44, v41, v44 quad_perm:[1,1,1,1] row_mask:0xf bank_mask:0xf
v_add_f32_dpp v45, v43, v45 quad_perm:[3,3,3,3] row_mask:0xf bank_mask:0xf
v_add_f32 v44, v44, v45
ds_write_b32 v61, v44 offset:192
s_waitcnt vmcnt(5)
s_cbranch_vccnz L_w44
s_waitcnt vmcnt(4)
L_w44:
buffer_load_dwordx4 v[64:67], v4, s[20:23], 0 offen nt
v_xor_b32 v4, 0x10200, v4
v_mfma_f32_16x16x32_bf16 v[36:39], v[192:195], v[16:19], 0
v_mfma_f32_16x16x32_bf16 v[36:39], v[196:199], v[20:23], v[36:39]
v_mfma_f32_16x16x32_bf16 v[36:39], v[200:203], v[24:27], v[36:39]
v_mfma_f32_16x16x32_bf16 v[36:39], v[204:207], v[28:31], v[36:39]
v_mfma_f32_16x16x32_bf16 v[40:43], v[208:211], v[16:19], 0
v_mfma_f32_16x16x32_bf16 v[40:43], v[212:215], v[20:23], v[40:43]
v_mfma_f32_16x16x32_bf16 v[40:43], v[216:219], v[24:27], v[40:43]
v_mfma_f32_16x16x32_bf16 v[40:43], v[220:223], v[28:31], v[40:43]
s_nop 3
v_mov_b32_dpp v44, v36 quad_perm:[0,0,0,0] row_mask:0xf bank_mask:0xf
v_mov_b32_dpp v45, v38 quad_perm:[2,2,2,2] row_mask:0xf bank_mask:0xf
s_nop 0
v_add_f32_dpp v44, v37, v44 quad_perm:[1,1,1,1] row_mask:0xf bank_mask:0xf
v_add_f32_dpp v45, v39, v45 quad_perm:[3,3,3,3] row_mask:0xf bank_mask:0xf
v_add_f32 v44, v44, v45
ds_write_b32 v61, v44 offset:256
v_mov_b32_dpp v44, v40 quad_perm:[0,0,0,0] row_mask:0xf bank_mask:0xf
v_mov_b32_dpp v45, v42 quad_perm:[2,2,2,2] row_mask:0xf bank_mask:0xf
s_nop 0
v_add_f32_dpp v44, v41, v44 quad_perm:[1,1,1,1] row_mask:0xf bank_mask:0xf
v_add_f32_dpp v45, v43, v45 quad_perm:[3,3,3,3] row_mask:0xf bank_mask:0xf
v_add_f32 v44, v44, v45
ds_write_b32 v61, v44 offset:320
s_branch L_po2
L_pad2:
s_setpc_b64 s[64:65]
L_po2:
s_waitcnt vmcnt(5)
s_cbranch_vccnz L_w45
s_waitcnt vmcnt(4)
L_w45:
buffer_load_dwordx4 v[68:71], v5, s[20:23], 0 offen nt
v_xor_b32 v5, 0x10200, v5
v_mfma_f32_16x16x32_bf16 v[36:39], v[224:227], v[16:19], 0
v_mfma_f32_16x16x32_bf16 v[36:39], v[228:231], v[20:23], v[36:39]
v_mfma_f32_16x16x32_bf16 v[36:39], v[232:235], v[24:27], v[36:39]
v_mfma_f32_16x16x32_bf16 v[36:39], v[236:239], v[28:31], v[36:39]
v_mfma_f32_16x16x32_bf16 v[40:43], v[240:243], v[16:19], 0
v_mfma_f32_16x16x32_bf16 v[40:43], v[244:247], v[20:23], v[40:43]
v_mfma_f32_16x16x32_bf16 v[40:43], v[248:251], v[24:27], v[40:43]
v_mfma_f32_16x16x32_bf16 v[40:43], v[252:255], v[28:31], v[40:43]
s_nop 3
v_mov_b32_dpp v44, v36 quad_perm:[0,0,0,0] row_mask:0xf bank_mask:0xf
v_mov_b32_dpp v45, v38 quad_perm:[2,2,2,2] row_mask:0xf bank_mask:0xf
s_nop 0
v_add_f32_dpp v44, v37, v44 quad_perm:[1,1,1,1] row_mask:0xf bank_mask:0xf
v_add_f32_dpp v45, v39, v45 quad_perm:[3,3,3,3] row_mask:0xf bank_mask:0xf
v_add_f32 v44, v44, v45
ds_write_b32 v61, v44 offset:384
v_mov_b32_dpp v44, v40 quad_perm:[0,0,0,0] row_mask:0xf bank_mask:0xf
v_mov_b32_dpp v45, v42 quad_perm:[2,2,2,2] row_mask:0xf bank_mask:0xf
s_nop 0
v_add_f32_dpp v44, v41, v44 quad_perm:[1,1,1,1] row_mask:0xf bank_mask:0xf
v_add_f32_dpp v45, v43, v45 quad_perm:[3,3,3,3] row_mask:0xf bank_mask:0xf
v_add_f32 v44, v44, v45
ds_write_b32 v61, v44 offset:448
v_add_u32 v61, 512, v61
s_mov_b32 s35, 6
s_mov_b32 s38, 0
s_mov_b32 s39, 3
ds_write_b32 v9, v11
ds_read_b32 v46, v9 offset:16
s_mov_b32 s30, 1
v_mfma_f32_16x16x32_bf16 v[36:39], v[96:99], v[16:19], 0
v_mfma_f32_16x16x32_bf16 v[36:39], v[100:103], v[20:23], v[36:39]
s_branch L_kslot10
L_pad3:
s_setpc_b64 s[64:65]
s_nop 0
.p2align 6
L_kloop:
s_cbranch_vccnz L_x46
s_waitcnt vmcnt(4)
L_w46:
buffer_load_dwordx4 v[96:99], v4, s[20:23], 0 offen nt
v_xor_b32 v4, 0x10200, v4
v_mfma_f32_16x16x32_bf16 v[36:39], v[64:67], v[16:19], 0
s_cbranch_vccnz L_x47
s_waitcnt vmcnt(4)
L_w47:
buffer_load_dwordx4 v[100:103], v5, s[20:23], 0 offen nt
v_xor_b32 v5, 0x10200, v5
v_mfma_f32_16x16x32_bf16 v[36:39], v[68:71], v[20:23], v[36:39]
s_cbranch_vccnz L_x48
s_waitcnt vmcnt(4)
L_w48:
buffer_load_dwordx4 v[104:107], v6, s[20:23], 0 offen nt
v_xor_b32 v6, 0x10200, v6
v_mfma_f32_16x16x32_bf16 v[36:39], v[72:75], v[24:27], v[36:39]
s_cbranch_vccnz L_x49
s_waitcnt vmcnt(4)
L_w49:
buffer_load_dwordx4 v[108:111], v7, s[20:23], 0 offen nt
v_xor_b32 v7, 0x10200, v7
s_add_u32 s39, s39, 1
s_mov_b32 s28, 0x8134300
s_bitcmp1_b32 s39, 2
s_cselect_b32 s28, 0x134300, s28
s_bitcmp1_b32 s39, 1
s_cselect_b32 s28, 0x1b4300, s28
s_bitcmp1_b32 s39, 0
s_cselect_b32 s28, 0x130700, s28
v_mfma_f32_16x16x32_bf16 v[36:39], v[76:79], v[28:31], v[36:39]
s_waitcnt lgkmcnt(0)
v_readfirstlane_b32 s30, v46
v_add_u32 v11, 1, v11
s_cmp_lg_u32 s30, 0
s_cselect_b64 vcc, -1, 0
s_nop 2
v_mov_b32_dpp v44, v36 quad_perm:[0,0,0,0] row_mask:0xf bank_mask:0xf
v_mov_b32_dpp v45, v38 quad_perm:[2,2,2,2] row_mask:0xf bank_mask:0xf
s_nop 0
v_add_f32_dpp v44, v37, v44 quad_perm:[1,1,1,1] row_mask:0xf bank_mask:0xf
v_add_f32_dpp v45, v39, v45 quad_perm:[3,3,3,3] row_mask:0xf bank_mask:0xf
v_add_f32 v44, v44, v45
ds_write_b32 v61, v44 offset:0
ds_write_b32 v9, v11
ds_read_b32 v46, v9 offset:16
s_cbranch_vccnz L_x50
s_waitcnt vmcnt(4)
L_w50:
buffer_load_dwordx4 v[112:115], v4, s[20:23], 0 offen nt
v_xor_b32 v4, s28, v4
v_mfma_f32_16x16x32_bf16 v[36:39], v[80:83], v[16:19], 0
s_cbranch_vccnz L_x51
s_waitcnt vmcnt(4)
L_w51:
buffer_load_dwordx4 v[116:119], v5, s[20:23], 0 offen nt
v_xor_b32 v5, s28, v5
v_mfma_f32_16x16x32_bf16 v[36:39], v[84:87], v[20:23], v[36:39]
s_cbranch_vccnz L_x52
s_waitcnt vmcnt(4)
L_w52:
buffer_load_dwordx4 v[120:123], v6, s[20:23], 0 offen nt
v_xor_b32 v6, s28, v6
v_mfma_f32_16x16x32_bf16 v[36:39], v[88:91], v[24:27], v[36:39]
s_cbranch_vccnz L_x53
s_waitcnt vmcnt(4)
L_w53:
buffer_load_dwordx4 v[124:127], v7, s[20:23], 0 offen nt
v_xor_b32 v7, s28, v7
s_cmp_eq_u32 s39, 16
s_cbranch_scc1 L_tov
L_tov_bk:
v_mfma_f32_16x16x32_bf16 v[36:39], v[92:95], v[28:31], v[36:39]
s_waitcnt lgkmcnt(0)
v_readfirstlane_b32 s30, v46
v_add_u32 v11, 1, v11
s_cmp_lg_u32 s30, 0
s_cselect_b64 vcc, -1, 0
s_nop 2
v_mov_b32_dpp v44, v36 quad_perm:[0,0,0,0] row_mask:0xf bank_mask:0xf
v_mov_b32_dpp v45, v38 quad_perm:[2,2,2,2] row_mask:0xf bank_mask:0xf
s_nop 0
v_add_f32_dpp v44, v37, v44 quad_perm:[1,1,1,1] row_mask:0xf bank_mask:0xf
v_add_f32_dpp v45, v39, v45 quad_perm:[3,3,3,3] row_mask:0xf bank_mask:0xf
v_add_f32 v44, v44, v45
ds_write_b32 v61, v44 offset:64
ds_write_b32 v9, v11
ds_read_b32 v46, v9 offset:16
s_cbranch_vccnz L_x54
s_waitcnt vmcnt(4)
L_w54:
buffer_load_dwordx4 v[64:67], v4, s[20:23], 0 offen nt
v_xor_b32 v4, 0x10200, v4
v_mfma_f32_16x16x32_bf16 v[36:39], v[96:99], v[16:19], 0
s_cbranch_vccnz L_x55
s_waitcnt vmcnt(4)
L_w55:
buffer_load_dwordx4 v[68:71], v5, s[20:23], 0 offen nt
v_xor_b32 v5, 0x10200, v5
v_mfma_f32_16x16x32_bf16 v[36:39], v[100:103], v[20:23], v[36:39]
L_kslot10:
s_cbranch_vccnz L_x56
s_waitcnt vmcnt(4)
L_w56:
buffer_load_dwordx4 v[72:75], v6, s[20:23], 0 offen nt
v_xor_b32 v6, 0x10200, v6
v_mfma_f32_16x16x32_bf16 v[36:39], v[104:107], v[24:27], v[36:39]
s_cbranch_vccnz L_x57
s_waitcnt vmcnt(4)
L_w57:
buffer_load_dwordx4 v[76:79], v7, s[20:23], 0 offen nt
v_xor_b32 v7, 0x10200, v7
v_mfma_f32_16x16x32_bf16 v[36:39], v[108:111], v[28:31], v[36:39]
s_waitcnt lgkmcnt(0)
v_readfirstlane_b32 s30, v46
v_add_u32 v11, 1, v11
s_cmp_lg_u32 s30, 0
s_cselect_b64 vcc, -1, 0
s_nop 2
v_mov_b32_dpp v44, v36 quad_perm:[0,0,0,0] row_mask:0xf bank_mask:0xf
v_mov_b32_dpp v45, v38 quad_perm:[2,2,2,2] row_mask:0xf bank_mask:0xf
s_nop 0
v_add_f32_dpp v44, v37, v44 quad_perm:[1,1,1,1] row_mask:0xf bank_mask:0xf
v_add_f32_dpp v45, v39, v45 quad_perm:[3,3,3,3] row_mask:0xf bank_mask:0xf
v_add_f32 v44, v44, v45
ds_write_b32 v61, v44 offset:128
ds_write_b32 v9, v11
ds_read_b32 v46, v9 offset:16
s_cbranch_vccnz L_x58
s_waitcnt vmcnt(4)
L_w58:
buffer_load_dwordx4 v[80:83], v4, s[20:23], 0 offen nt
v_xor_b32 v4, 0x30700, v4
v_mfma_f32_16x16x32_bf16 v[36:39], v[112:115], v[16:19], 0
s_cbranch_vccnz L_x59
s_waitcnt vmcnt(4)
L_w59:
buffer_load_dwordx4 v[84:87], v5, s[20:23], 0 offen nt
v_xor_b32 v5, 0x30700, v5
v_mfma_f32_16x16x32_bf16 v[36:39], v[116:119], v[20:23], v[36:39]
s_cbranch_vccnz L_x60
s_waitcnt vmcnt(4)
L_w60:
buffer_load_dwordx4 v[88:91], v6, s[20:23], 0 offen nt
v_xor_b32 v6, 0x30700, v6
v_mfma_f32_16x16x32_bf16 v[36:39], v[120:123], v[24:27], v[36:39]
s_cbranch_vccnz L_x61
s_waitcnt vmcnt(4)
L_w61:
buffer_load_dwordx4 v[92:95], v7, s[20:23], 0 offen nt
v_xor_b32 v7, 0x30700, v7
v_mfma_f32_16x16x32_bf16 v[36:39], v[124:127], v[28:31], v[36:39]
s_waitcnt lgkmcnt(0)
v_readfirstlane_b32 s30, v46
v_add_u32 v11, 1, v11
s_cmp_lg_u32 s30, 0
s_cselect_b64 vcc, -1, 0
s_nop 2
v_mov_b32_dpp v44, v36 quad_perm:[0,0,0,0] row_mask:0xf bank_mask:0xf
v_mov_b32_dpp v45, v38 quad_perm:[2,2,2,2] row_mask:0xf bank_mask:0xf
s_nop 0
v_add_f32_dpp v44, v37, v44 quad_perm:[1,1,1,1] row_mask:0xf bank_mask:0xf
v_add_f32_dpp v45, v39, v45 quad_perm:[3,3,3,3] row_mask:0xf bank_mask:0xf
v_add_f32 v44, v44, v45
ds_write_b32 v61, v44 offset:192
ds_write_b32 v9, v11
ds_read_b32 v46, v9 offset:16
v_add_u32 v61, 256, v61
s_sub_u32 s35, s35, 1
s_cmp_lg_u32 s35, 0
s_cbranch_scc1 L_kloop
s_cmp_eq_u32 s38, 0
s_cbranch_scc1 L_kswitch
s_mov_b32 s38, 8
L_vbatch:
v_cmp_eq_u32 s[40:41], 0, v60
v_cmp_eq_u32 s[42:43], 1, v60
v_cmp_eq_u32 s[44:45], 2, v60
v_cmp_eq_u32 s[46:47], 3, v60
s_mov_b32 s35, 20000000
L_rdy:
ds_read_b32 v1, v10
ds_read_b128 v[48:51], v62
ds_read_b32 v17, v47
v_cndmask_b32 v12, 0, v55, s[40:41]
v_cndmask_b32 v13, 0, v55, s[42:43]
v_cndmask_b32 v14, 0, v55, s[44:45]
v_cndmask_b32 v15, 0, v55, s[46:47]
s_waitcnt lgkmcnt(0)
v_readfirstlane_b32 s29, v1
s_sub_u32 s35, s35, 1
s_cbranch_scc1 L_rdyok
s_cmp_eq_u32 s29, 0
s_cbranch_scc1 L_rdy
L_rdyok:
v_and_b32 v40, v48, v12
v_and_b32 v41, v48, v13
v_and_b32 v42, v48, v14
v_and_b32 v43, v48, v15
s_mov_b32 s35, s38
v_lshrrev_b32 v17, s57, v17
v_and_b32 v16, 63, v17
v_bfe_u32 v17, v17, 6, 6
s_branch L_po6
L_pad6:
s_setpc_b64 s[64:65]
L_po6:
.p2align 6
L_vloop:
s_cbranch_vccnz L_x62
s_waitcnt vmcnt(4)
L_w62:
buffer_load_dwordx4 v[96:99], v4, s[20:23], 0 offen nt
v_xor_b32 v4, 0x10200, v4
v_mfma_f32_16x16x32_bf16 v[32:35], v[40:43], v[64:67], v[32:35]
ds_read_b128 v[56:59], v62 offset:64
v_and_b32 v40, v49, v12
v_and_b32 v41, v49, v13
v_and_b32 v42, v49, v14
v_and_b32 v43, v49, v15
s_cbranch_vccnz L_x63
s_waitcnt vmcnt(4)
L_w63:
buffer_load_dwordx4 v[100:103], v5, s[20:23], 0 offen nt
v_xor_b32 v5, 0x10200, v5
v_mfma_f32_16x16x32_bf16 v[32:35], v[40:43], v[68:71], v[32:35]
v_and_b32 v40, v50, v12
v_and_b32 v41, v50, v13
v_and_b32 v42, v50, v14
v_and_b32 v43, v50, v15
s_cbranch_vccnz L_x64
s_waitcnt vmcnt(4)
L_w64:
buffer_load_dwordx4 v[104:107], v6, s[20:23], 0 offen nt
v_xor_b32 v6, 0x10200, v6
v_mfma_f32_16x16x32_bf16 v[32:35], v[40:43], v[72:75], v[32:35]
v_and_b32 v40, v51, v12
v_and_b32 v41, v51, v13
v_and_b32 v42, v51, v14
v_and_b32 v43, v51, v15
s_cbranch_vccnz L_x65
s_waitcnt vmcnt(4)
L_w65:
buffer_load_dwordx4 v[108:111], v7, s[20:23], 0 offen nt
v_xor_b32 v7, 0x10200, v7
s_add_u32 s39, s39, 1
s_mov_b32 s28, 0x8134300
s_bitcmp1_b32 s39, 2
s_cselect_b32 s28, 0x134300, s28
s_bitcmp1_b32 s39, 1
s_cselect_b32 s28, 0x1b4300, s28
s_bitcmp1_b32 s39, 0
s_cselect_b32 s28, 0x130700, s28
v_mfma_f32_16x16x32_bf16 v[32:35], v[40:43], v[76:79], v[32:35]
s_waitcnt lgkmcnt(0)
v_readfirstlane_b32 s30, v46
v_add_u32 v11, 1, v11
s_cmp_lg_u32 s30, 0
s_cselect_b64 vcc, -1, 0
ds_write_b32 v9, v11
ds_read_b32 v46, v9 offset:16
v_and_b32 v40, v56, v12
v_and_b32 v41, v56, v13
v_and_b32 v42, v56, v14
v_and_b32 v43, v56, v15
s_cbranch_vccnz L_x66
s_waitcnt vmcnt(4)
L_w66:
buffer_load_dwordx4 v[112:115], v4, s[20:23], 0 offen nt
v_xor_b32 v4, s28, v4
v_mfma_f32_16x16x32_bf16 v[32:35], v[40:43], v[80:83], v[32:35]
ds_read_b128 v[48:51], v62 offset:128
v_and_b32 v40, v57, v12
v_and_b32 v41, v57, v13
v_and_b32 v42, v57, v14
v_and_b32 v43, v57, v15
s_cbranch_vccnz L_x67
s_waitcnt vmcnt(4)
L_w67:
buffer_load_dwordx4 v[116:119], v5, s[20:23], 0 offen nt
v_xor_b32 v5, s28, v5
v_mfma_f32_16x16x32_bf16 v[32:35], v[40:43], v[84:87], v[32:35]
v_and_b32 v40, v58, v12
v_and_b32 v41, v58, v13
v_and_b32 v42, v58, v14
v_and_b32 v43, v58, v15
s_cbranch_vccnz L_x68
s_waitcnt vmcnt(4)
L_w68:
buffer_load_dwordx4 v[120:123], v6, s[20:23], 0 offen nt
v_xor_b32 v6, s28, v6
v_mfma_f32_16x16x32_bf16 v[32:35], v[40:43], v[88:91], v[32:35]
v_and_b32 v40, v59, v12
v_and_b32 v41, v59, v13
v_and_b32 v42, v59, v14
v_and_b32 v43, v59, v15
s_cbranch_vccnz L_x69
s_waitcnt vmcnt(4)
L_w69:
buffer_load_dwordx4 v[124:127], v7, s[20:23], 0 offen nt
v_xor_b32 v7, s28, v7
v_mfma_f32_16x16x32_bf16 v[32:35], v[40:43], v[92:95], v[32:35]
s_waitcnt lgkmcnt(0)
v_readfirstlane_b32 s30, v46
v_add_u32 v11, 1, v11
s_cmp_lg_u32 s30, 0
s_cselect_b64 vcc, -1, 0
ds_write_b32 v9, v11
ds_read_b32 v46, v9 offset:16
v_and_b32 v40, v48, v12
v_and_b32 v41, v48, v13
v_and_b32 v42, v48, v14
v_and_b32 v43, v48, v15
s_cbranch_vccnz L_x70
s_waitcnt vmcnt(4)
L_w70:
buffer_load_dwordx4 v[64:67], v4, s[20:23], 0 offen nt
v_xor_b32 v4, 0x10200, v4
v_mfma_f32_16x16x32_bf16 v[32:35], v[40:43], v[96:99], v[32:35]
ds_read_b128 v[56:59], v62 offset:192
v_and_b32 v40, v49, v12
v_and_b32 v41, v49, v13
v_and_b32 v42, v49, v14
v_and_b32 v43, v49, v15
s_cbranch_vccnz L_x71
s_waitcnt vmcnt(4)
L_w71:
buffer_load_dwordx4 v[68:71], v5, s[20:23], 0 offen nt
v_xor_b32 v5, 0x10200, v5
v_mfma_f32_16x16x32_bf16 v[32:35], v[40:43], v[100:103], v[32:35]
v_and_b32 v40, v50, v12
v_and_b32 v41, v50, v13
v_and_b32 v42, v50, v14
v_and_b32 v43, v50, v15
s_cbranch_vccnz L_x72
s_waitcnt vmcnt(4)
L_w72:
buffer_load_dwordx4 v[72:75], v6, s[20:23], 0 offen nt
v_xor_b32 v6, 0x10200, v6
v_mfma_f32_16x16x32_bf16 v[32:35], v[40:43], v[104:107], v[32:35]
v_and_b32 v40, v51, v12
v_and_b32 v41, v51, v13
v_and_b32 v42, v51, v14
v_and_b32 v43, v51, v15
s_cbranch_vccnz L_x73
s_waitcnt vmcnt(4)
L_w73:
buffer_load_dwordx4 v[76:79], v7, s[20:23], 0 offen nt
v_xor_b32 v7, 0x10200, v7
v_mfma_f32_16x16x32_bf16 v[32:35], v[40:43], v[108:111], v[32:35]
s_waitcnt lgkmcnt(0)
v_readfirstlane_b32 s30, v46
v_add_u32 v11, 1, v11
s_cmp_lg_u32 s30, 0
s_cselect_b64 vcc, -1, 0
ds_write_b32 v9, v11
ds_read_b32 v46, v9 offset:16
v_and_b32 v40, v56, v12
v_and_b32 v41, v56, v13
v_and_b32 v42, v56, v14
v_and_b32 v43, v56, v15
s_cbranch_vccnz L_x74
s_waitcnt vmcnt(4)
L_w74:
buffer_load_dwordx4 v[80:83], v4, s[20:23], 0 offen nt
v_xor_b32 v4, 0x30700, v4
v_mfma_f32_16x16x32_bf16 v[32:35], v[40:43], v[112:115], v[32:35]
ds_read_b128 v[48:51], v62 offset:256
v_and_b32 v40, v57, v12
v_and_b32 v41, v57, v13
v_and_b32 v42, v57, v14
v_and_b32 v43, v57, v15
s_cbranch_vccnz L_x75
s_waitcnt vmcnt(4)
L_w75:
buffer_load_dwordx4 v[84:87], v5, s[20:23], 0 offen nt
v_xor_b32 v5, 0x30700, v5
v_mfma_f32_16x16x32_bf16 v[32:35], v[40:43], v[116:119], v[32:35]
v_and_b32 v40, v58, v12
v_and_b32 v41, v58, v13
v_and_b32 v42, v58, v14
v_and_b32 v43, v58, v15
s_cbranch_vccnz L_x76
s_waitcnt vmcnt(4)
L_w76:
buffer_load_dwordx4 v[88:91], v6, s[20:23], 0 offen nt
v_xor_b32 v6, 0x30700, v6
v_mfma_f32_16x16x32_bf16 v[32:35], v[40:43], v[120:123], v[32:35]
v_and_b32 v40, v59, v12
v_and_b32 v41, v59, v13
v_and_b32 v42, v59, v14
v_and_b32 v43, v59, v15
s_cbranch_vccnz L_x77
s_waitcnt vmcnt(4)
L_w77:
buffer_load_dwordx4 v[92:95], v7, s[20:23], 0 offen nt
v_xor_b32 v7, 0x30700, v7
v_mfma_f32_16x16x32_bf16 v[32:35], v[40:43], v[124:127], v[32:35]
s_waitcnt lgkmcnt(0)
v_readfirstlane_b32 s30, v46
v_add_u32 v11, 1, v11
s_cmp_lg_u32 s30, 0
s_cselect_b64 vcc, -1, 0
ds_write_b32 v9, v11
ds_read_b32 v46, v9 offset:16
v_and_b32 v40, v48, v12
v_and_b32 v41, v48, v13
v_and_b32 v42, v48, v14
v_and_b32 v43, v48, v15
v_add_u32 v62, 256, v62
s_sub_u32 s35, s35, 1
s_cmp_lg_u32 s35, 0
s_cbranch_scc1 L_vloop
s_cmp_eq_u32 s38, 8
s_cbranch_scc1 L_vswitch
s_mov_b32 s35, 8000000
s_branch L_po9
L_pad9:
s_setpc_b64 s[64:65]
L_po9:
s_cbranch_vccnz L_x78
s_waitcnt vmcnt(4)
L_w78:
buffer_load_dwordx4 v[96:99], v4, s[20:23], 0 offen nt
v_xor_b32 v4, 0x10200, v4
v_mfma_f32_16x16x32_bf16 v[32:35], v[40:43], v[64:67], v[32:35]
ds_read_b128 v[56:59], v62 offset:64
v_and_b32 v40, v49, v12
v_and_b32 v41, v49, v13
v_and_b32 v42, v49, v14
v_and_b32 v43, v49, v15
s_cbranch_vccnz L_x79
s_waitcnt vmcnt(4)
L_w79:
buffer_load_dwordx4 v[100:103], v5, s[20:23], 0 offen nt
v_xor_b32 v5, 0x10200, v5
v_mfma_f32_16x16x32_bf16 v[32:35], v[40:43], v[68:71], v[32:35]
v_and_b32 v40, v50, v12
v_and_b32 v41, v50, v13
v_and_b32 v42, v50, v14
v_and_b32 v43, v50, v15
s_cbranch_vccnz L_x80
s_waitcnt vmcnt(4)
L_w80:
buffer_load_dwordx4 v[104:107], v6, s[20:23], 0 offen nt
v_xor_b32 v6, 0x10200, v6
v_mfma_f32_16x16x32_bf16 v[32:35], v[40:43], v[72:75], v[32:35]
v_and_b32 v40, v51, v12
v_and_b32 v41, v51, v13
v_and_b32 v42, v51, v14
v_and_b32 v43, v51, v15
s_cbranch_vccnz L_x81
s_waitcnt vmcnt(4)
L_w81:
buffer_load_dwordx4 v[108:111], v7, s[20:23], 0 offen nt
v_xor_b32 v7, 0x10200, v7
v_mfma_f32_16x16x32_bf16 v[32:35], v[40:43], v[76:79], v[32:35]
s_waitcnt lgkmcnt(0)
v_readfirstlane_b32 s30, v46
v_add_u32 v11, 1, v11
s_cmp_lg_u32 s30, 0
s_cselect_b64 vcc, -1, 0
v_and_b32 v40, v56, v12
v_and_b32 v41, v56, v13
v_and_b32 v42, v56, v14
v_and_b32 v43, v56, v15
s_cbranch_vccnz L_x82
s_waitcnt vmcnt(4)
L_w82:
buffer_load_dwordx4 v[112:115], v4, s[20:23], 0 offen nt
v_mfma_f32_16x16x32_bf16 v[32:35], v[40:43], v[80:83], v[32:35]
ds_read_b128 v[48:51], v62 offset:128
v_and_b32 v40, v57, v12
v_and_b32 v41, v57, v13
v_and_b32 v42, v57, v14
v_and_b32 v43, v57, v15
s_cbranch_vccnz L_x83
s_waitcnt vmcnt(4)
L_w83:
buffer_load_dwordx4 v[116:119], v5, s[20:23], 0 offen nt
v_mfma_f32_16x16x32_bf16 v[32:35], v[40:43], v[84:87], v[32:35]
v_and_b32 v40, v58, v12
v_and_b32 v41, v58, v13
v_and_b32 v42, v58, v14
v_and_b32 v43, v58, v15
s_cbranch_vccnz L_x84
s_waitcnt vmcnt(4)
L_w84:
buffer_load_dwordx4 v[120:123], v6, s[20:23], 0 offen nt
v_mfma_f32_16x16x32_bf16 v[32:35], v[40:43], v[88:91], v[32:35]
v_and_b32 v40, v59, v12
v_and_b32 v41, v59, v13
v_and_b32 v42, v59, v14
v_and_b32 v43, v59, v15
s_cbranch_vccnz L_x85
s_waitcnt vmcnt(4)
L_w85:
buffer_load_dwordx4 v[124:127], v7, s[20:23], 0 offen nt
v_mfma_f32_16x16x32_bf16 v[32:35], v[40:43], v[92:95], v[32:35]
s_waitcnt lgkmcnt(0)
v_and_b32 v40, v48, v12
v_and_b32 v41, v48, v13
v_and_b32 v42, v48, v14
v_and_b32 v43, v48, v15
s_branch L_po11
L_pad11:
s_setpc_b64 s[64:65]
L_po11:
s_waitcnt vmcnt(7)
s_nop 0
v_mfma_f32_16x16x32_bf16 v[32:35], v[40:43], v[96:99], v[32:35]
ds_read_b128 v[56:59], v62 offset:192
v_and_b32 v40, v49, v12
v_and_b32 v41, v49, v13
v_and_b32 v42, v49, v14
v_and_b32 v43, v49, v15
s_waitcnt vmcnt(6)
s_nop 0
v_mfma_f32_16x16x32_bf16 v[32:35], v[40:43], v[100:103], v[32:35]
v_and_b32 v40, v50, v12
v_and_b32 v41, v50, v13
v_and_b32 v42, v50, v14
v_and_b32 v43, v50, v15
s_waitcnt vmcnt(5)
s_nop 0
v_mfma_f32_16x16x32_bf16 v[32:35], v[40:43], v[104:107], v[32:35]
v_and_b32 v40, v51, v12
v_and_b32 v41, v51, v13
v_and_b32 v42, v51, v14
v_and_b32 v43, v51, v15
s_waitcnt vmcnt(4)
s_nop 0
v_mfma_f32_16x16x32_bf16 v[32:35], v[40:43], v[108:111], v[32:35]
s_waitcnt lgkmcnt(0)
v_and_b32 v40, v56, v12
v_and_b32 v41, v56, v13
v_and_b32 v42, v56, v14
v_and_b32 v43, v56, v15
s_waitcnt vmcnt(3)
s_nop 0
v_mfma_f32_16x16x32_bf16 v[32:35], v[40:43], v[112:115], v[32:35]
buffer_load_dwordx4 v[64:67], v3, s[24:27], s56 offen nt
s_add_u32 s56, s56, 5120
buffer_load_dwordx4 v[68:71], v3, s[24:27], s56 offen nt
s_add_u32 s56, s56, 5120
v_and_b32 v40, v57, v12
v_and_b32 v41, v57, v13
v_and_b32 v42, v57, v14
v_and_b32 v43, v57, v15
s_waitcnt vmcnt(4)
s_nop 0
v_mfma_f32_16x16x32_bf16 v[32:35], v[40:43], v[116:119], v[32:35]
buffer_load_dwordx4 v[72:75], v3, s[24:27], s56 offen nt
s_add_u32 s56, s56, 5120
buffer_load_dwordx4 v[76:79], v3, s[24:27], s56 offen nt
s_add_u32 s56, s56, 5120
v_and_b32 v40, v58, v12
v_and_b32 v41, v58, v13
v_and_b32 v42, v58, v14
v_and_b32 v43, v58, v15
s_waitcnt vmcnt(5)
s_nop 0
v_mfma_f32_16x16x32_bf16 v[32:35], v[40:43], v[120:123], v[32:35]
v_and_b32 v40, v59, v12
v_and_b32 v41, v59, v13
v_and_b32 v42, v59, v14
v_and_b32 v43, v59, v15
s_waitcnt vmcnt(4)
s_nop 0
v_mfma_f32_16x16x32_bf16 v[32:35], v[40:43], v[124:127], v[32:35]
v_cndmask_b32 v12, 0, v55, s[64:65]
v_cndmask_b32 v13, 0, v55, s[66:67]
v_cndmask_b32 v14, 0, v55, s[68:69]
v_cndmask_b32 v15, 0, v55, s[70:71]
s_nop 3
ds_write_b128 v63, v[32:35]
s_waitcnt lgkmcnt(0)
s_barrier
s_cmp_ge_u32 s34, 5
s_cbranch_scc1 L_sfin
buffer_load_dwordx4 v[80:83], v3, s[24:27], s56 offen nt
s_add_u32 s56, s56, 5120
buffer_load_dwordx4 v[84:87], v3, s[24:27], s56 offen nt
s_add_u32 s56, s56, 5120
buffer_load_dwordx4 v[88:91], v3, s[24:27], s56 offen nt
s_add_u32 s56, s56, 5120
buffer_load_dwordx4 v[92:95], v3, s[24:27], s56 offen nt
s_waitcnt vmcnt(2)
L_go2:
buffer_load_dwordx4 v[160:163], v2, s[60:63], 0 offen offset:0 sc1
buffer_load_dwordx4 v[164:167], v2, s[60:63], 0 offen offset:128 sc1
s_waitcnt vmcnt(1)
v_xor_b32 v144, v160, v16
v_xor_b32 v145, v161, v16
v_xor_b32 v146, v162, v16
v_xor_b32 v147, v163, v16
v_or3_b32 v1, v144, v145, 0
v_or3_b32 v1, v146, v147, v1
s_waitcnt vmcnt(0)
v_xor_b32 v148, v164, v17
v_xor_b32 v149, v165, v17
v_xor_b32 v150, v166, v17
v_xor_b32 v151, v167, v17
v_or3_b32 v1, v148, v149, v1
v_or3_b32 v1, v150, v151, v1
v_and_b32 v1, 63, v1
v_cmp_ne_u32 vcc, 0, v1
v_permlane32_swap_b32 v144, v145
v_permlane32_swap_b32 v146, v147
v_permlane32_swap_b32 v148, v149
v_permlane32_swap_b32 v150, v151
s_cbranch_vccz L_go2_ok
s_sub_u32 s35, s35, 1
s_cbranch_scc0 L_go2
s_branch L_po12
L_pad12:
s_setpc_b64 s[64:65]
L_po12:
.p2align 3
L_go2_ok:
v_add_f32 v144, v144, v145
v_add_f32 v146, v146, v147
v_add_f32 v148, v148, v149
v_add_f32 v150, v150, v151
v_permlane16_swap_b32 v144, v146
s_nop 0
v_permlane16_swap_b32 v148, v150
v_add_f32 v144, v144, v146
v_add_f32 v148, v148, v150
s_nop 0
v_add_f32_dpp v144, v144, v144 row_ror:8 row_mask:0xf bank_mask:0xf
v_add_f32_dpp v148, v148, v148 row_ror:8 row_mask:0xf bank_mask:0xf
v_cvt_pk_bf16_f32 v144, v144, v144
v_cvt_pk_bf16_f32 v148, v148, v148
s_nop 0
s_nop 0
v_and_b32_dpp v40, v144, v12 quad_perm:[0,0,0,0] row_mask:0xf bank_mask:0xf
v_and_b32_dpp v41, v144, v13 quad_perm:[0,0,0,0] row_mask:0xf bank_mask:0xf
v_and_b32_dpp v42, v144, v14 quad_perm:[0,0,0,0] row_mask:0xf bank_mask:0xf
v_and_b32_dpp v43, v144, v15 quad_perm:[0,0,0,0] row_mask:0xf bank_mask:0xf
v_and_b32_dpp v36, v144, v12 quad_perm:[1,1,1,1] row_mask:0xf bank_mask:0xf
v_and_b32_dpp v37, v144, v13 quad_perm:[1,1,1,1] row_mask:0xf bank_mask:0xf
v_and_b32_dpp v38, v144, v14 quad_perm:[1,1,1,1] row_mask:0xf bank_mask:0xf
v_and_b32_dpp v39, v144, v15 quad_perm:[1,1,1,1] row_mask:0xf bank_mask:0xf
v_mfma_f32_16x16x32_bf16 v[32:35], v[40:43], v[64:67], 0
v_and_b32_dpp v40, v144, v12 quad_perm:[2,2,2,2] row_mask:0xf bank_mask:0xf
v_and_b32_dpp v41, v144, v13 quad_perm:[2,2,2,2] row_mask:0xf bank_mask:0xf
v_and_b32_dpp v42, v144, v14 quad_perm:[2,2,2,2] row_mask:0xf bank_mask:0xf
v_and_b32_dpp v43, v144, v15 quad_perm:[2,2,2,2] row_mask:0xf bank_mask:0xf
v_mfma_f32_16x16x32_bf16 v[32:35], v[36:39], v[68:71], v[32:35]
v_and_b32_dpp v36, v144, v12 quad_perm:[3,3,3,3] row_mask:0xf bank_mask:0xf
v_and_b32_dpp v37, v144, v13 quad_perm:[3,3,3,3] row_mask:0xf bank_mask:0xf
v_and_b32_dpp v38, v144, v14 quad_perm:[3,3,3,3] row_mask:0xf bank_mask:0xf
v_and_b32_dpp v39, v144, v15 quad_perm:[3,3,3,3] row_mask:0xf bank_mask:0xf
v_mfma_f32_16x16x32_bf16 v[32:35], v[40:43], v[72:75], v[32:35]
v_and_b32_dpp v40, v148, v12 quad_perm:[0,0,0,0] row_mask:0xf bank_mask:0xf
v_and_b32_dpp v41, v148, v13 quad_perm:[0,0,0,0] row_mask:0xf bank_mask:0xf
v_and_b32_dpp v42, v148, v14 quad_perm:[0,0,0,0] row_mask:0xf bank_mask:0xf
v_and_b32_dpp v43, v148, v15 quad_perm:[0,0,0,0] row_mask:0xf bank_mask:0xf
v_mfma_f32_16x16x32_bf16 v[32:35], v[36:39], v[76:79], v[32:35]
v_and_b32_dpp v36, v148, v12 quad_perm:[1,1,1,1] row_mask:0xf bank_mask:0xf
v_and_b32_dpp v37, v148, v13 quad_perm:[1,1,1,1] row_mask:0xf bank_mask:0xf
v_and_b32_dpp v38, v148, v14 quad_perm:[1,1,1,1] row_mask:0xf bank_mask:0xf
v_and_b32_dpp v39, v148, v15 quad_perm:[1,1,1,1] row_mask:0xf bank_mask:0xf
v_mfma_f32_16x16x32_bf16 v[32:35], v[40:43], v[80:83], v[32:35]
v_and_b32_dpp v40, v148, v12 quad_perm:[2,2,2,2] row_mask:0xf bank_mask:0xf
v_and_b32_dpp v41, v148, v13 quad_perm:[2,2,2,2] row_mask:0xf bank_mask:0xf
v_and_b32_dpp v42, v148, v14 quad_perm:[2,2,2,2] row_mask:0xf bank_mask:0xf
v_and_b32_dpp v43, v148, v15 quad_perm:[2,2,2,2] row_mask:0xf bank_mask:0xf
v_mfma_f32_16x16x32_bf16 v[32:35], v[36:39], v[84:87], v[32:35]
v_and_b32_dpp v36, v148, v12 quad_perm:[3,3,3,3] row_mask:0xf bank_mask:0xf
v_and_b32_dpp v37, v148, v13 quad_perm:[3,3,3,3] row_mask:0xf bank_mask:0xf
v_and_b32_dpp v38, v148, v14 quad_perm:[3,3,3,3] row_mask:0xf bank_mask:0xf
v_and_b32_dpp v39, v148, v15 quad_perm:[3,3,3,3] row_mask:0xf bank_mask:0xf
v_mfma_f32_16x16x32_bf16 v[32:35], v[40:43], v[88:91], v[32:35]
s_nop 1
v_mfma_f32_16x16x32_bf16 v[32:35], v[36:39], v[92:95], v[32:35]
s_nop 7
ds_write_b128 v53, v[32:35]
s_waitcnt lgkmcnt(0)
s_barrier
L_sfin:
L_end:
s_endpgm
L_pad13:
s_setpc_b64 s[64:65]
s_nop 0
L_kswitch:
v_cndmask_b32 v16, 0, v48, s[48:49]
v_cndmask_b32 v17, 0, v49, s[48:49]
v_cndmask_b32 v18, 0, v50, s[48:49]
v_cndmask_b32 v19, 0, v51, s[48:49]
v_cndmask_b32 v20, 0, v48, s[50:51]
v_cndmask_b32 v21, 0, v49, s[50:51]
v_cndmask_b32 v22, 0, v50, s[50:51]
v_cndmask_b32 v23, 0, v51, s[50:51]
v_cndmask_b32 v24, 0, v48, s[52:53]
v_cndmask_b32 v25, 0, v49, s[52:53]
v_cndmask_b32 v26, 0, v50, s[52:53]
v_cndmask_b32 v27, 0, v51, s[52:53]
v_cndmask_b32 v28, 0, v48, s[54:55]
v_cndmask_b32 v29, 0, v49, s[54:55]
v_cndmask_b32 v30, 0, v50, s[54:55]
v_cndmask_b32 v31, 0, v51, s[54:55]
v_add_u32 v61, 6144, v61
s_mov_b32 s35, 8
s_mov_b32 s38, 1
s_branch L_kloop
L_vswitch:
v_add_u32 v62, 6144, v62
v_add_u32 v10, 4, v10
v_subrev_u32 v60, 4, v60
s_mov_b32 s38, 7
s_branch L_vbatch
L_pad4:
s_setpc_b64 s[64:65]
s_nop 0
L_x46:
s_waitcnt vmcnt(6)
s_cmp_eq_u32 s30, 3
s_cbranch_scc1 L_w46
s_waitcnt vmcnt(5)
s_branch L_w46
L_x47:
s_waitcnt vmcnt(6)
s_cmp_eq_u32 s30, 3
s_cbranch_scc1 L_w47
s_waitcnt vmcnt(5)
s_branch L_w47
L_x48:
s_waitcnt vmcnt(6)
s_cmp_eq_u32 s30, 3
s_cbranch_scc1 L_w48
s_waitcnt vmcnt(5)
s_branch L_w48
L_x49:
s_waitcnt vmcnt(6)
s_cmp_eq_u32 s30, 3
s_cbranch_scc1 L_w49
s_waitcnt vmcnt(5)
s_branch L_w49
L_x50:
s_waitcnt vmcnt(6)
s_cmp_eq_u32 s30, 3
s_cbranch_scc1 L_w50
s_waitcnt vmcnt(5)
s_branch L_w50
L_x51:
s_waitcnt vmcnt(6)
s_cmp_eq_u32 s30, 3
s_cbranch_scc1 L_w51
s_waitcnt vmcnt(5)
s_branch L_w51
L_x52:
s_waitcnt vmcnt(6)
s_cmp_eq_u32 s30, 3
s_cbranch_scc1 L_w52
s_waitcnt vmcnt(5)
s_branch L_w52
L_x53:
s_waitcnt vmcnt(6)
s_cmp_eq_u32 s30, 3
s_cbranch_scc1 L_w53
s_waitcnt vmcnt(5)
s_branch L_w53
L_pad5:
s_setpc_b64 s[64:65]
s_nop 0
L_x54:
s_waitcnt vmcnt(6)
s_cmp_eq_u32 s30, 3
s_cbranch_scc1 L_w54
s_waitcnt vmcnt(5)
s_branch L_w54
L_x55:
s_waitcnt vmcnt(6)
s_cmp_eq_u32 s30, 3
s_cbranch_scc1 L_w55
s_waitcnt vmcnt(5)
s_branch L_w55
L_x56:
s_waitcnt vmcnt(6)
s_cmp_eq_u32 s30, 3
s_cbranch_scc1 L_w56
s_waitcnt vmcnt(5)
s_branch L_w56
L_x57:
s_waitcnt vmcnt(6)
s_cmp_eq_u32 s30, 3
s_cbranch_scc1 L_w57
s_waitcnt vmcnt(5)
s_branch L_w57
L_x58:
s_waitcnt vmcnt(6)
s_cmp_eq_u32 s30, 3
s_cbranch_scc1 L_w58
s_waitcnt vmcnt(5)
s_branch L_w58
L_x59:
s_waitcnt vmcnt(6)
s_cmp_eq_u32 s30, 3
s_cbranch_scc1 L_w59
s_waitcnt vmcnt(5)
s_branch L_w59
L_x60:
s_waitcnt vmcnt(6)
s_cmp_eq_u32 s30, 3
s_cbranch_scc1 L_w60
s_waitcnt vmcnt(5)
s_branch L_w60
L_x61:
s_waitcnt vmcnt(6)
s_cmp_eq_u32 s30, 3
s_cbranch_scc1 L_w61
s_waitcnt vmcnt(5)
s_branch L_w61
L_tov:
s_mov_b32 s20, s36
s_mov_b32 s21, s37
v_xor_b32 v4, v8, v4
v_xor_b32 v5, v8, v5
v_xor_b32 v6, v8, v6
v_xor_b32 v7, v8, v7
s_branch L_tov_bk
L_pad7:
s_setpc_b64 s[64:65]
s_nop 0
L_x62:
s_waitcnt vmcnt(6)
s_cmp_eq_u32 s30, 3
s_cbranch_scc1 L_w62
s_waitcnt vmcnt(5)
s_branch L_w62
L_x63:
s_waitcnt vmcnt(6)
s_cmp_eq_u32 s30, 3
s_cbranch_scc1 L_w63
s_waitcnt vmcnt(5)
s_branch L_w63
L_x64:
s_waitcnt vmcnt(6)
s_cmp_eq_u32 s30, 3
s_cbranch_scc1 L_w64
s_waitcnt vmcnt(5)
s_branch L_w64
L_x65:
s_waitcnt vmcnt(6)
s_cmp_eq_u32 s30, 3
s_cbranch_scc1 L_w65
s_waitcnt vmcnt(5)
s_branch L_w65
L_x66:
s_waitcnt vmcnt(6)
s_cmp_eq_u32 s30, 3
s_cbranch_scc1 L_w66
s_waitcnt vmcnt(5)
s_branch L_w66
L_x67:
s_waitcnt vmcnt(6)
s_cmp_eq_u32 s30, 3
s_cbranch_scc1 L_w67
s_waitcnt vmcnt(5)
s_branch L_w67
L_x68:
s_waitcnt vmcnt(6)
s_cmp_eq_u32 s30, 3
s_cbranch_scc1 L_w68
s_waitcnt vmcnt(5)
s_branch L_w68
L_x69:
s_waitcnt vmcnt(6)
s_cmp_eq_u32 s30, 3
s_cbranch_scc1 L_w69
s_waitcnt vmcnt(5)
s_branch L_w69
L_pad8:
s_setpc_b64 s[64:65]
s_nop 0
L_x70:
s_waitcnt vmcnt(6)
s_cmp_eq_u32 s30, 3
s_cbranch_scc1 L_w70
s_waitcnt vmcnt(5)
s_branch L_w70
L_x71:
s_waitcnt vmcnt(6)
s_cmp_eq_u32 s30, 3
s_cbranch_scc1 L_w71
s_waitcnt vmcnt(5)
s_branch L_w71
L_x72:
s_waitcnt vmcnt(6)
s_cmp_eq_u32 s30, 3
s_cbranch_scc1 L_w72
s_waitcnt vmcnt(5)
s_branch L_w72
L_x73:
s_waitcnt vmcnt(6)
s_cmp_eq_u32 s30, 3
s_cbranch_scc1 L_w73
s_waitcnt vmcnt(5)
s_branch L_w73
L_x74:
s_waitcnt vmcnt(6)
s_cmp_eq_u32 s30, 3
s_cbranch_scc1 L_w74
s_waitcnt vmcnt(5)
s_branch L_w74
L_x75:
s_waitcnt vmcnt(6)
s_cmp_eq_u32 s30, 3
s_cbranch_scc1 L_w75
s_waitcnt vmcnt(5)
s_branch L_w75
L_x76:
s_waitcnt vmcnt(6)
s_cmp_eq_u32 s30, 3
s_cbranch_scc1 L_w76
s_waitcnt vmcnt(5)
s_branch L_w76
L_x77:
s_waitcnt vmcnt(6)
s_cmp_eq_u32 s30, 3
s_cbranch_scc1 L_w77
s_waitcnt vmcnt(5)
s_branch L_w77
L_pad10:
s_setpc_b64 s[64:65]
s_nop 0
L_x78:
s_waitcnt vmcnt(6)
s_cmp_eq_u32 s30, 3
s_cbranch_scc1 L_w78
s_waitcnt vmcnt(5)
s_branch L_w78
L_x79:
s_waitcnt vmcnt(6)
s_cmp_eq_u32 s30, 3
s_cbranch_scc1 L_w79
s_waitcnt vmcnt(5)
s_branch L_w79
L_x80:
s_waitcnt vmcnt(6)
s_cmp_eq_u32 s30, 3
s_cbranch_scc1 L_w80
s_waitcnt vmcnt(5)
s_branch L_w80
L_x81:
s_waitcnt vmcnt(6)
s_cmp_eq_u32 s30, 3
s_cbranch_scc1 L_w81
s_waitcnt vmcnt(5)
s_branch L_w81
L_x82:
s_waitcnt vmcnt(6)
s_cmp_eq_u32 s30, 3
s_cbranch_scc1 L_w82
s_waitcnt vmcnt(5)
s_branch L_w82
L_x83:
s_waitcnt vmcnt(6)
s_cmp_eq_u32 s30, 3
s_cbranch_scc1 L_w83
s_waitcnt vmcnt(5)
s_branch L_w83
L_x84:
s_waitcnt vmcnt(6)
s_cmp_eq_u32 s30, 3
s_cbranch_scc1 L_w84
s_waitcnt vmcnt(5)
s_branch L_w84
L_x85:
s_waitcnt vmcnt(6)
s_cmp_eq_u32 s30, 3
s_cbranch_scc1 L_w85
s_waitcnt vmcnt(5)
s_branch L_w85
.p2align 6
L_service:
v_lshlrev_b32 v4, 4, v0
v_lshlrev_b32 v5, 2, v0
v_and_b32 v21, 1, v0
v_and_b32 v22, 7, v0
v_and_b32 v23, 3, v0
v_mov_b32 v19, 1
v_mov_b32 v52, 0
v_lshlrev_b32 v9, 2, v23
v_add_u32 v9, 5120, v9
s_cmp_eq_u32 s3, 5
s_cbranch_scc1 L_balance
s_setprio 3
s_mul_i32 s29, s33, 80128
s_mov_b32 s43, 0x20000
s_mov_b32 s42, 15360
v_mov_b32 v28, -1
v_mov_b32 v29, -1
v_mov_b32 v30, -1
v_mov_b32 v31, -1
s_mov_b32 s46, 4
s_mov_b32 s47, 0x20000
s_mul_i32 s31, s33, 384
s_mov_b32 s22, 2560
s_mov_b32 s23, 0x20000
s_mov_b32 s58, 12288
s_mov_b32 s59, 0x20000
s_waitcnt lgkmcnt(0)
s_add_u32 s40, s18, s29
s_addc_u32 s41, s19, 0
s_add_u32 s56, s18, 0x3000000
s_addc_u32 s57, s19, 0
s_mov_b32 s44, s16
s_mov_b32 s45, s17
s_mov_b32 s20, s4
s_mov_b32 s21, s5
s_cmp_lg_u32 s2, 0
s_cbranch_scc1 L_noclr
s_mov_b32 s30, 0
buffer_store_dwordx4 v[28:31], v4, s[56:59], s30 offen offset:0 sc1
buffer_store_dwordx4 v[28:31], v4, s[56:59], s30 offen offset:1024 sc1
buffer_store_dwordx4 v[28:31], v4, s[56:59], s30 offen offset:2048 sc1
buffer_store_dwordx4 v[28:31], v4, s[56:59], s30 offen offset:3072 sc1
s_add_u32 s30, s30, 4096
buffer_store_dwordx4 v[28:31], v4, s[56:59], s30 offen offset:0 sc1
buffer_store_dwordx4 v[28:31], v4, s[56:59], s30 offen offset:1024 sc1
buffer_store_dwordx4 v[28:31], v4, s[56:59], s30 offen offset:2048 sc1
buffer_store_dwordx4 v[28:31], v4, s[56:59], s30 offen offset:3072 sc1
s_add_u32 s30, s30, 4096
buffer_store_dwordx4 v[28:31], v4, s[56:59], s30 offen offset:0 sc1
buffer_store_dwordx4 v[28:31], v4, s[56:59], s30 offen offset:1024 sc1
buffer_store_dwordx4 v[28:31], v4, s[56:59], s30 offen offset:2048 sc1
buffer_store_dwordx4 v[28:31], v4, s[56:59], s30 offen offset:3072 sc1
s_add_u32 s30, s30, 4096
s_waitcnt vmcnt(0)
buffer_store_dword v19, v5, s[44:47], 0 offen sc1
L_noclr:
ds_write_b32 v5, v52 offset:5120
s_lshl_b32 s30, s34, 10
v_add_u32 v14, s30, v4
v_add_u32 v15, 8192, v14
v_bfe_u32 v6, v0, 3, 2
v_mul_u32_u24 v6, 6, v6
s_cmp_lt_u32 s39, 4
s_cbranch_scc1 L_noq
s_and_b32 s30, s39, 1
s_mul_i32 s38, s30, 640
s_bfe_u32 s29, s39, 0x10001
s_lshl1_add_u32 s30, s30, s29
s_lshl_b32 s30, s30, 9
s_add_u32 s30, s30, 13312
v_and_b32 v8, 0x1ff, v4
buffer_load_dwordx4 v[32:35], v8, s[40:43], s30 offen sc1
s_mov_b32 m0, 5632
s_mov_b32 s29, 1024
buffer_load_dwordx4 v4, s[20:23], 0 offen lds
s_mov_b32 m0, 6656
s_nop 0
buffer_load_dwordx4 v4, s[20:23], s29 offen lds
s_mov_b32 m0, 7168
s_mov_b32 s29, 1536
buffer_load_dwordx4 v4, s[20:23], s29 offen lds
v_lshrrev_b32 v1, 1, v2
v_cmp_eq_u32 s[48:49], 1, v1
v_cmp_eq_u32 s[50:51], 2, v1
v_cmp_eq_u32 s[52:53], 3, v1
v_lshrrev_b32 v8, 2, v2
v_lshl_add_u32 v8, v3, 3, v8
v_lshlrev_b32 v8, 7, v8
v_lshl_add_u32 v8, v23, 3, v8
v_mul_u32_u24 v10, 0x500, v21
v_lshl_add_u32 v10, v3, 4, v10
v_add_u32 v10, s38, v10
v_lshlrev_b32 v11, 7, v3
v_lshl_add_u32 v11, v22, 4, v11
v_bfe_u32 v1, v0, 3, 1
v_lshl_add_u32 v11, v1, 24, v11
s_lshl_b32 s29, s39, 2
v_lshl_add_u32 v18, v0, 24, s29
v_mov_b32 v192, 0
v_mov_b32 v193, 0
v_mov_b32 v194, 0
v_mov_b32 v195, 0
v_mov_b32 v196, 0
v_mov_b32 v197, 0
v_mov_b32 v198, 0
v_mov_b32 v199, 0
v_mov_b32 v200, 0
v_mov_b32 v201, 0
v_mov_b32 v202, 0
v_mov_b32 v203, 0
v_mov_b32 v204, 0
v_mov_b32 v205, 0
v_mov_b32 v206, 0
v_mov_b32 v207, 0
s_waitcnt vmcnt(0)
v_bfe_u32 v1, v32, 5, 1
v_xor_b32 v1, 1, v1
v_lshlrev_b32 v32, v32, v1
v_bfe_u32 v1, v33, 5, 1
v_xor_b32 v1, 1, v1
v_lshlrev_b32 v33, v33, v1
v_bfe_u32 v1, v34, 5, 1
v_xor_b32 v1, 1, v1
v_lshlrev_b32 v34, v34, v1
v_bfe_u32 v1, v35, 5, 1
v_xor_b32 v1, 1, v1
v_lshlrev_b32 v35, v35, v1
v_or_b32 v1, v32, v33
v_or3_b32 v1, v34, v35, v1
s_nop 1
v_or_b32_dpp v1, v1, v1 quad_perm:[1,0,3,2] row_mask:0xf bank_mask:0xf
s_nop 1
v_or_b32_dpp v1, v1, v1 quad_perm:[2,3,0,1] row_mask:0xf bank_mask:0xf
s_nop 1
v_or_b32_dpp v1, v1, v1 row_half_mirror row_mask:0xf bank_mask:0xf
v_not_b32 v1, v1
v_ffbl_b32 v1, v1
v_min_u32 v32, 32, v1
v_lshlrev_b32 v33, v6, v32
s_nop 1
v_or_b32_dpp v33, v33, v33 row_ror:8 row_mask:0xf bank_mask:0xf
v_mov_b32 v1, v33
s_nop 1
v_permlane16_swap_b32 v33, v1
v_or_b32 v33, v33, v1
v_mul_u32_u24 v1, 6, v3
v_bfe_u32 v32, v33, v1, 6
s_mov_b32 s38, 4
s_waitcnt lgkmcnt(0)
s_barrier
buffer_load_dword v20, v52, s[44:47], 0 offen sc1
ds_read_b128 v[128:131], v10 offset:5632
ds_read_b64_tr_b16 v[64:65], v8 offset:24576
ds_read_b64_tr_b16 v[66:67], v8 offset:25088
ds_read_b64_tr_b16 v[68:69], v8 offset:24608
ds_read_b64_tr_b16 v[70:71], v8 offset:25120
ds_read_b64_tr_b16 v[72:73], v8 offset:24640
ds_read_b64_tr_b16 v[74:75], v8 offset:25152
ds_read_b64_tr_b16 v[76:77], v8 offset:24672
ds_read_b64_tr_b16 v[78:79], v8 offset:25184
L_qp:
s_waitcnt lgkmcnt(6)
ds_read_b128 v[132:135], v10 offset:5696
ds_read_b64_tr_b16 v[80:81], v8 offset:28672
ds_read_b64_tr_b16 v[82:83], v8 offset:29184
ds_read_b64_tr_b16 v[84:85], v8 offset:28704
ds_read_b64_tr_b16 v[86:87], v8 offset:29216
ds_read_b64_tr_b16 v[88:89], v8 offset:28736
ds_read_b64_tr_b16 v[90:91], v8 offset:29248
ds_read_b64_tr_b16 v[92:93], v8 offset:28768
ds_read_b64_tr_b16 v[94:95], v8 offset:29280
s_waitcnt lgkmcnt(9)
v_mfma_f32_16x16x32_bf16 v[192:195], v[64:67], v[128:131], v[192:195]
v_mfma_f32_16x16x32_bf16 v[196:199], v[68:71], v[128:131], v[196:199]
v_mfma_f32_16x16x32_bf16 v[200:203], v[72:75], v[128:131], v[200:203]
v_mfma_f32_16x16x32_bf16 v[204:207], v[76:79], v[128:131], v[204:207]
s_waitcnt lgkmcnt(6)
ds_read_b128 v[128:131], v10 offset:5760
ds_read_b64_tr_b16 v[64:65], v8 offset:32768
ds_read_b64_tr_b16 v[66:67], v8 offset:33280
ds_read_b64_tr_b16 v[68:69], v8 offset:32800
ds_read_b64_tr_b16 v[70:71], v8 offset:33312
ds_read_b64_tr_b16 v[72:73], v8 offset:32832
ds_read_b64_tr_b16 v[74:75], v8 offset:33344
ds_read_b64_tr_b16 v[76:77], v8 offset:32864
ds_read_b64_tr_b16 v[78:79], v8 offset:33376
s_waitcnt lgkmcnt(9)
v_mfma_f32_16x16x32_bf16 v[192:195], v[80:83], v[132:135], v[192:195]
v_mfma_f32_16x16x32_bf16 v[196:199], v[84:87], v[132:135], v[196:199]
v_mfma_f32_16x16x32_bf16 v[200:203], v[88:91], v[132:135], v[200:203]
v_mfma_f32_16x16x32_bf16 v[204:207], v[92:95], v[132:135], v[204:207]
v_add_u32 v8, 0x2000, v8
v_add_u32 v10, 0x80, v10
s_sub_u32 s38, s38, 1
s_cbranch_scc0 L_qp
s_nop 3
v_cndmask_b32 v192, v192, v196, s[48:49]
v_cndmask_b32 v193, v193, v197, s[48:49]
v_cndmask_b32 v194, v194, v198, s[48:49]
v_cndmask_b32 v195, v195, v199, s[48:49]
v_cndmask_b32 v192, v192, v200, s[50:51]
v_cndmask_b32 v193, v193, v201, s[50:51]
v_cndmask_b32 v194, v194, v202, s[50:51]
v_cndmask_b32 v195, v195, v203, s[50:51]
v_cndmask_b32 v192, v192, v204, s[52:53]
v_cndmask_b32 v193, v193, v205, s[52:53]
v_cndmask_b32 v194, v194, v206, s[52:53]
v_cndmask_b32 v195, v195, v207, s[52:53]
v_bfi_b32 v192, 63, v32, v192
v_bfi_b32 v193, 63, v32, v193
v_bfi_b32 v194, 63, v32, v194
v_bfi_b32 v195, 63, v32, v195
buffer_store_dwordx4 v[192:195], v11, s[40:43], s30 offen sc1
s_waitcnt vmcnt(1)
v_cmp_eq_u32 vcc, 0, v20
s_cbranch_vccz L_goq_ok
s_mov_b32 s63, 1000000
s_branch L_goq_in
L_goq:
s_sleep 16
L_goq_in:
buffer_load_dword v1, v52, s[44:47], 0 offen sc1
s_waitcnt vmcnt(0)
s_sub_u32 s63, s63, 1
s_cbranch_scc1 L_goq_ok
v_cmp_eq_u32 vcc, 0, v1
s_cbranch_vccnz L_goq
L_goq_ok:
buffer_store_dword v33, v18, s[56:59], s31 offen offset:240 sc1
L_noq:
v_mov_b32 v60, 0
v_mov_b32 v61, 0
v_mov_b32 v62, 0
v_mov_b32 v63, 0
buffer_load_dwordx4 v[56:59], v14, s[40:43], 0 offen sc1
s_cmp_ge_u32 s34, 5
s_cbranch_scc1 L_noy
buffer_load_dwordx4 v[60:63], v15, s[40:43], 0 offen sc1
L_noy:
s_waitcnt vmcnt(0)
v_bfe_u32 v1, v56, 5, 1
v_xor_b32 v1, 1, v1
v_lshlrev_b32 v56, v56, v1
v_bfe_u32 v1, v57, 5, 1
v_xor_b32 v1, 1, v1
v_lshlrev_b32 v57, v57, v1
v_bfe_u32 v1, v58, 5, 1
v_xor_b32 v1, 1, v1
v_lshlrev_b32 v58, v58, v1
v_bfe_u32 v1, v59, 5, 1
v_xor_b32 v1, 1, v1
v_lshlrev_b32 v59, v59, v1
v_or_b32 v1, v56, v57
v_or3_b32 v1, v58, v59, v1
s_nop 1
v_or_b32_dpp v1, v1, v1 quad_perm:[1,0,3,2] row_mask:0xf bank_mask:0xf
s_nop 1
v_or_b32_dpp v1, v1, v1 quad_perm:[2,3,0,1] row_mask:0xf bank_mask:0xf
s_nop 1
v_or_b32_dpp v1, v1, v1 row_half_mirror row_mask:0xf bank_mask:0xf
v_not_b32 v1, v1
v_ffbl_b32 v1, v1
v_min_u32 v56, 32, v1
v_lshlrev_b32 v24, v6, v56
s_nop 1
v_or_b32_dpp v24, v24, v24 row_ror:8 row_mask:0xf bank_mask:0xf
v_mov_b32 v1, v24
s_nop 1
v_permlane16_swap_b32 v24, v1
v_or_b32 v24, v24, v1
v_mov_b32 v25, v24
s_nop 1
v_permlane32_swap_b32 v24, v25
v_bfe_u32 v1, v60, 5, 1
v_xor_b32 v1, 1, v1
v_lshlrev_b32 v60, v60, v1
v_bfe_u32 v1, v61, 5, 1
v_xor_b32 v1, 1, v1
v_lshlrev_b32 v61, v61, v1
v_bfe_u32 v1, v62, 5, 1
v_xor_b32 v1, 1, v1
v_lshlrev_b32 v62, v62, v1
v_bfe_u32 v1, v63, 5, 1
v_xor_b32 v1, 1, v1
v_lshlrev_b32 v63, v63, v1
v_or_b32 v1, v60, v61
v_or3_b32 v1, v62, v63, v1
s_nop 1
v_or_b32_dpp v1, v1, v1 quad_perm:[1,0,3,2] row_mask:0xf bank_mask:0xf
s_nop 1
v_or_b32_dpp v1, v1, v1 quad_perm:[2,3,0,1] row_mask:0xf bank_mask:0xf
s_nop 1
v_or_b32_dpp v1, v1, v1 row_half_mirror row_mask:0xf bank_mask:0xf
v_not_b32 v1, v1
v_ffbl_b32 v1, v1
v_min_u32 v57, 32, v1
v_lshlrev_b32 v26, v6, v57
s_nop 1
v_or_b32_dpp v26, v26, v26 row_ror:8 row_mask:0xf bank_mask:0xf
v_mov_b32 v1, v26
s_nop 1
v_permlane16_swap_b32 v26, v1
v_or_b32 v26, v26, v1
v_mov_b32 v27, v26
s_nop 1
v_permlane32_swap_b32 v26, v27
s_cmp_ge_u32 s39, 4
s_cbranch_scc1 L_go_ok
s_mov_b32 s63, 1000000
s_branch L_go_in
L_go:
s_sleep 16
L_go_in:
buffer_load_dword v1, v52, s[44:47], 0 offen sc1
s_waitcnt vmcnt(0)
s_sub_u32 s63, s63, 1
s_cbranch_scc1 L_go_ok
v_cmp_eq_u32 vcc, 0, v1
s_cbranch_vccnz L_go
L_go_ok:
v_lshrrev_b32 v1, 5, v0
v_lshlrev_b32 v8, 3, v1
v_lshlrev_b32 v10, 7, v1
v_lshl_add_u32 v10, v21, 8, v10
v_bfe_u32 v1, v0, 1, 2
v_lshl_add_u32 v10, v1, 5, v10
v_and_b32 v1, 24, v0
v_add_u32 v10, v1, v10
s_mov_b32 s30, 13312
s_mov_b32 s63, 1000000
s_branch L_lq_in
L_lq:
s_sleep 16
L_lq_in:
buffer_load_dwordx2 v[40:41], v8, s[56:59], s31 offen offset:256 sc1
buffer_load_dwordx4 v[32:35], v4, s[40:43], s30 offen sc1
buffer_load_dwordx4 v[36:39], v4, s[40:43], s30 offen offset:1024 sc1
s_waitcnt vmcnt(0)
s_sub_u32 s63, s63, 1
s_cbranch_scc1 L_lq_ok
v_or_b32 v1, v40, v41
v_lshrrev_b32 v1, 24, v1
v_bfe_u32 v40, v40, v6, 6
v_bfe_u32 v41, v41, v6, 6
v_xor_b32 v32, v32, v40
v_xor_b32 v33, v33, v40
v_xor_b32 v34, v34, v40
v_xor_b32 v35, v35, v40
v_xor_b32 v36, v36, v41
v_xor_b32 v37, v37, v41
v_xor_b32 v38, v38, v41
v_xor_b32 v39, v39, v41
v_or3_b32 v1, v32, v33, v1
v_or3_b32 v1, v34, v35, v1
v_or3_b32 v1, v36, v37, v1
v_or3_b32 v1, v38, v39, v1
v_and_b32 v1, 63, v1
v_cmp_ne_u32 vcc, 0, v1
s_cbranch_vccnz L_lq
L_lq_ok:
v_lshlrev_b32 v8, 3, v0
v_add_f32 v32, v32, v36
v_add_f32 v33, v33, v37
v_add_f32 v34, v34, v38
v_add_f32 v35, v35, v39
v_cvt_pk_bf16_f32 v36, v32, v33
v_cvt_pk_bf16_f32 v37, v34, v35
ds_write_b64 v10, v[36:37] offset:4096
s_waitcnt lgkmcnt(0)
s_barrier
s_setprio 0
v_and_b32 v6, 1, v3
v_lshrrev_b32 v7, 3, v0
s_getreg_b32 s35, hwreg(HW_REG_XCC_ID, 0, 4)
v_lshl_or_b32 v27, s35, 24, v27
s_mov_b32 s8, s18
s_mov_b32 s9, s19
s_mov_b32 s10, 2564096
s_mov_b32 s11, 0x20000
v_lshrrev_b32 v43, 1, v0
v_mul_u32_u24 v44, 80128, v43
v_lshl_add_u32 v44, v21, 4, v44
s_lshl_b32 s30, s34, 5
s_add_u32 s30, s30, s33
s_lshl_b32 s30, s30, 5
s_add_u32 s30, s30, 8192
v_add_u32 v44, s30, v44
v_lshrrev_b32 v20, 1, v3
v_lshl_add_u32 v20, v6, 1, v20
v_lshl_add_u32 v20, v21, 2, v20
s_lshr_b32 s30, s33, 2
s_lshl3_add_u32 s30, s34, s30
s_and_b32 s29, s33, 1
s_lshl1_add_u32 s30, s30, s29
s_lshl_b32 s30, s30, 3
s_bitcmp1_b32 s33, 1
s_cselect_b32 s29, 0x280, 0
s_add_u32 s30, s30, s29
v_add_lshl_u32 v20, v20, s30, 1
v_lshrrev_b32 v1, 1, v2
v_lshl_add_u32 v20, v1, 24, v20
s_mov_b32 s20, s14
s_mov_b32 s21, s15
s_lshl_b32 s30, s34, 5
v_lshrrev_b32 v1, 1, v0
v_lshl_add_u32 v13, v1, 24, s30
v_lshl_add_u32 v13, v21, 4, v13
v_lshrrev_b32 v12, 5, v0
v_lshlrev_b32 v12, 3, v12
v_lshl_add_u32 v12, v22, 5, v12
v_lshlrev_b32 v18, 5, v7
s_cmp_lt_u32 s34, 5
s_cselect_b32 s30, s30, 0x1000000
v_mul_u32_u24 v43, 384, v43
v_add_u32 v43, s30, v43
s_mov_b32 s32, 0x3e0293ee
v_add_u32 v11, 8192, v4
v_mov_b32 v10, 5152
s_call_b64 s[64:65], L_pad6
s_call_b64 s[64:65], L_pad7
s_call_b64 s[64:65], L_pad8
s_call_b64 s[64:65], L_pad9
s_call_b64 s[64:65], L_pad10
s_call_b64 s[64:65], L_pad11
s_call_b64 s[64:65], L_pad12
s_call_b64 s[64:65], L_pad13
s_call_b64 s[64:65], L_pad14
s_mov_b32 s62, 32
L_soft:
s_mov_b32 s63, 2500000
s_branch L_done_in
L_done:
s_sleep 16
L_done_in:
ds_read_b32 v1, v9
s_waitcnt lgkmcnt(0)
s_sub_u32 s63, s63, 1
s_cbranch_scc1 L_done_ok
v_cmp_gt_u32 vcc, s62, v1
s_cbranch_vccnz L_done
L_done_ok:
ds_read_b128 v[192:195], v11 offset:0
ds_read_b128 v[196:199], v11 offset:1024
ds_read_b128 v[200:203], v11 offset:2048
ds_read_b128 v[204:207], v11 offset:3072
ds_read_b128 v[208:211], v11 offset:4096
ds_read_b128 v[212:215], v11 offset:5120
ds_read_b128 v[216:219], v11 offset:6144
ds_read_b128 v[220:223], v11 offset:7168
v_mov_b32 v28, v30
v_mov_b32 v29, v31
s_waitcnt lgkmcnt(0)
v_max_f32 v30, v192, v193
v_max3_f32 v30, v194, v195, v30
v_max3_f32 v30, v196, v197, v30
v_max3_f32 v30, v198, v199, v30
v_max3_f32 v30, v200, v201, v30
v_max3_f32 v30, v202, v203, v30
v_max3_f32 v30, v204, v205, v30
v_max3_f32 v30, v206, v207, v30
v_max3_f32 v30, v208, v209, v30
v_max3_f32 v30, v210, v211, v30
v_max3_f32 v30, v212, v213, v30
v_max3_f32 v30, v214, v215, v30
v_max3_f32 v30, v216, v217, v30
v_max3_f32 v30, v218, v219, v30
v_max3_f32 v30, v220, v221, v30
v_max3_f32 v30, v222, v223, v30
s_nop 1
v_max_f32_dpp v30, v30, v30 quad_perm:[1,0,3,2] row_mask:0xf bank_mask:0xf
s_nop 1
v_max_f32_dpp v30, v30, v30 quad_perm:[2,3,0,1] row_mask:0xf bank_mask:0xf
s_nop 1
v_max_f32_dpp v30, v30, v30 row_half_mirror row_mask:0xf bank_mask:0xf
s_nop 1
v_max_f32_dpp v30, v30, v30 row_mirror row_mask:0xf bank_mask:0xf
v_mov_b32 v1, v30
s_nop 1
v_permlane16_swap_b32 v30, v1
v_max_f32 v30, v30, v1
v_mov_b32 v1, v30
s_nop 1
v_permlane32_swap_b32 v30, v1
v_max_f32 v30, v30, v1
v_mul_f32 v30, s32, v30
v_fma_f32 v192, v192, s32, -v30
v_fma_f32 v193, v193, s32, -v30
v_fma_f32 v194, v194, s32, -v30
v_fma_f32 v195, v195, s32, -v30
v_fma_f32 v196, v196, s32, -v30
v_fma_f32 v197, v197, s32, -v30
v_fma_f32 v198, v198, s32, -v30
v_fma_f32 v199, v199, s32, -v30
v_fma_f32 v200, v200, s32, -v30
v_fma_f32 v201, v201, s32, -v30
v_fma_f32 v202, v202, s32, -v30
v_fma_f32 v203, v203, s32, -v30
v_fma_f32 v204, v204, s32, -v30
v_fma_f32 v205, v205, s32, -v30
v_fma_f32 v206, v206, s32, -v30
v_fma_f32 v207, v207, s32, -v30
v_fma_f32 v208, v208, s32, -v30
v_fma_f32 v209, v209, s32, -v30
v_fma_f32 v210, v210, s32, -v30
v_fma_f32 v211, v211, s32, -v30
v_fma_f32 v212, v212, s32, -v30
v_fma_f32 v213, v213, s32, -v30
v_fma_f32 v214, v214, s32, -v30
v_fma_f32 v215, v215, s32, -v30
v_fma_f32 v216, v216, s32, -v30
v_fma_f32 v217, v217, s32, -v30
v_fma_f32 v218, v218, s32, -v30
v_fma_f32 v219, v219, s32, -v30
v_fma_f32 v220, v220, s32, -v30
v_fma_f32 v221, v221, s32, -v30
v_fma_f32 v222, v222, s32, -v30
v_fma_f32 v223, v223, s32, -v30
v_exp_f32 v192, v192
v_exp_f32 v193, v193
v_exp_f32 v194, v194
v_exp_f32 v195, v195
v_exp_f32 v196, v196
v_exp_f32 v197, v197
v_exp_f32 v198, v198
v_exp_f32 v199, v199
v_exp_f32 v200, v200
v_exp_f32 v201, v201
v_exp_f32 v202, v202
v_exp_f32 v203, v203
v_exp_f32 v204, v204
v_exp_f32 v205, v205
v_exp_f32 v206, v206
v_exp_f32 v207, v207
v_exp_f32 v208, v208
v_exp_f32 v209, v209
v_exp_f32 v210, v210
v_exp_f32 v211, v211
v_exp_f32 v212, v212
v_exp_f32 v213, v213
v_exp_f32 v214, v214
v_exp_f32 v215, v215
v_exp_f32 v216, v216
v_exp_f32 v217, v217
v_exp_f32 v218, v218
v_exp_f32 v219, v219
v_exp_f32 v220, v220
v_exp_f32 v221, v221
v_exp_f32 v222, v222
v_exp_f32 v223, v223
v_add_f32 v31, v192, v193
v_add_f32 v31, v31, v194
v_add_f32 v31, v31, v195
v_add_f32 v31, v31, v196
v_add_f32 v31, v31, v197
v_add_f32 v31, v31, v198
v_add_f32 v31, v31, v199
v_add_f32 v31, v31, v200
v_add_f32 v31, v31, v201
v_add_f32 v31, v31, v202
v_add_f32 v31, v31, v203
v_add_f32 v31, v31, v204
v_add_f32 v31, v31, v205
v_add_f32 v31, v31, v206
v_add_f32 v31, v31, v207
v_add_f32 v31, v31, v208
v_add_f32 v31, v31, v209
v_add_f32 v31, v31, v210
v_add_f32 v31, v31, v211
v_add_f32 v31, v31, v212
v_add_f32 v31, v31, v213
v_add_f32 v31, v31, v214
v_add_f32 v31, v31, v215
v_add_f32 v31, v31, v216
v_add_f32 v31, v31, v217
v_add_f32 v31, v31, v218
v_add_f32 v31, v31, v219
v_add_f32 v31, v31, v220
v_add_f32 v31, v31, v221
v_add_f32 v31, v31, v222
v_add_f32 v31, v31, v223
v_cvt_pk_bf16_f32 v192, v192, v192
v_cvt_pk_bf16_f32 v193, v193, v193
v_cvt_pk_bf16_f32 v194, v194, v194
v_cvt_pk_bf16_f32 v195, v195, v195
v_cvt_pk_bf16_f32 v196, v196, v196
v_cvt_pk_bf16_f32 v197, v197, v197
v_cvt_pk_bf16_f32 v198, v198, v198
v_cvt_pk_bf16_f32 v199, v199, v199
v_cvt_pk_bf16_f32 v200, v200, v200
v_cvt_pk_bf16_f32 v201, v201, v201
v_cvt_pk_bf16_f32 v202, v202, v202
v_cvt_pk_bf16_f32 v203, v203, v203
v_cvt_pk_bf16_f32 v204, v204, v204
v_cvt_pk_bf16_f32 v205, v205, v205
v_cvt_pk_bf16_f32 v206, v206, v206
v_cvt_pk_bf16_f32 v207, v207, v207
v_cvt_pk_bf16_f32 v208, v208, v208
v_cvt_pk_bf16_f32 v209, v209, v209
v_cvt_pk_bf16_f32 v210, v210, v210
v_cvt_pk_bf16_f32 v211, v211, v211
v_cvt_pk_bf16_f32 v212, v212, v212
v_cvt_pk_bf16_f32 v213, v213, v213
v_cvt_pk_bf16_f32 v214, v214, v214
v_cvt_pk_bf16_f32 v215, v215, v215
v_cvt_pk_bf16_f32 v216, v216, v216
v_cvt_pk_bf16_f32 v217, v217, v217
v_cvt_pk_bf16_f32 v218, v218, v218
v_cvt_pk_bf16_f32 v219, v219, v219
v_cvt_pk_bf16_f32 v220, v220, v220
v_cvt_pk_bf16_f32 v221, v221, v221
v_cvt_pk_bf16_f32 v222, v222, v222
v_cvt_pk_bf16_f32 v223, v223, v223
ds_write_b128 v11, v[192:195] offset:0
ds_write_b128 v11, v[196:199] offset:1024
ds_write_b128 v11, v[200:203] offset:2048
ds_write_b128 v11, v[204:207] offset:3072
ds_write_b128 v11, v[208:211] offset:4096
ds_write_b128 v11, v[212:215] offset:5120
ds_write_b128 v11, v[216:219] offset:6144
ds_write_b128 v11, v[220:223] offset:7168
ds_write_b32 v10, v19
s_nop 1
v_add_f32_dpp v31, v31, v31 quad_perm:[1,0,3,2] row_mask:0xf bank_mask:0xf
s_nop 1
v_add_f32_dpp v31, v31, v31 quad_perm:[2,3,0,1] row_mask:0xf bank_mask:0xf
s_nop 1
v_add_f32_dpp v31, v31, v31 row_half_mirror row_mask:0xf bank_mask:0xf
s_nop 1
v_add_f32_dpp v31, v31, v31 row_mirror row_mask:0xf bank_mask:0xf
v_mov_b32 v1, v31
s_nop 1
v_permlane16_swap_b32 v31, v1
v_add_f32 v31, v31, v1
v_mov_b32 v1, v31
s_nop 1
v_permlane32_swap_b32 v31, v1
v_add_f32 v31, v31, v1
v_min_u32 v30, -2, v30
v_min_u32 v31, -2, v31
v_add_u32 v11, 0x2000, v11
s_add_u32 s62, s62, 32
s_cmp_eq_u32 s62, 64
s_cbranch_scc1 L_soft
v_cmp_eq_u32 vcc, 0, v0
s_nop 1
v_cndmask_b32 v24, v24, v28, vcc
v_cndmask_b32 v25, v25, v29, vcc
v_cndmask_b32 v26, v26, v30, vcc
v_cndmask_b32 v27, v27, v31, vcc
buffer_store_dwordx4 v[24:27], v13, s[56:59], s31 offen sc1
s_mov_b32 s63, 2500000
s_branch L_late_in
L_late:
s_sleep 16
L_late_in:
ds_read_b32 v1, v9
s_waitcnt lgkmcnt(0)
s_sub_u32 s63, s63, 1
s_cbranch_scc1 L_late_ok
v_cmp_gt_u32 vcc, 84, v1
s_cbranch_vccnz L_late
L_late_ok:
s_mov_b32 s63, 1000000
s_branch L_ml_in
L_ml:
s_sleep 64
L_ml_in:
buffer_load_dwordx2 v[36:37], v12, s[56:59], s31 offen sc1
buffer_load_dwordx2 v[38:39], v18, s[56:59], s31 offen offset:16 sc1
buffer_load_dwordx2 v[48:49], v43, s[56:59], 0 offen offset:24 sc1
s_waitcnt vmcnt(0)
s_sub_u32 s63, s63, 1
s_cbranch_scc1 L_ml_ok
v_max_u32 v1, v36, v37
v_max3_u32 v1, v38, v39, v1
v_max3_u32 v1, v48, v49, v1
v_cmp_eq_u32 vcc, -1, v1
s_cbranch_vccnz L_ml
L_ml_ok:
v_lshrrev_b32 v42, 24, v49
v_xor_b32 v42, s35, v42
s_nop 1
v_or_b32_dpp v42, v42, v42 quad_perm:[2,3,0,1] row_mask:0xf bank_mask:0xf
s_nop 1
v_or_b32_dpp v42, v42, v42 row_half_mirror row_mask:0xf bank_mask:0xf
v_cmp_eq_u32 vcc, 0, v42
v_or_b32 v42, 0x1000000, v15
s_nop 0
v_cndmask_b32 v53, v15, v42, vcc
v_cndmask_b32 v15, v42, v15, vcc
s_bitcmp1_b32 s33, 4
s_cselect_b64 vcc, -1, 0
s_bfe_u32 s30, s33, 0x20002
s_mul_i32 s30, s30, 6
v_cndmask_b32 v48, v48, v49, vcc
v_bfe_u32 v48, v48, s30, 6
ds_write_b64 v8, v[38:39] offset:4608
ds_write_b32 v10, v19 offset:4
v_cmp_le_u32 vcc, 32, v0
v_max_f32_dpp v40, v36, v36 quad_perm:[1,0,3,2] row_mask:0xf bank_mask:0xf
s_nop 1
v_max_f32_dpp v40, v40, v40 quad_perm:[2,3,0,1] row_mask:0xf bank_mask:0xf
v_cndmask_b32 v28, v28, v30, vcc
s_nop 0
v_max_f32_dpp v40, v40, v40 row_half_mirror row_mask:0xf bank_mask:0xf
v_sub_f32 v36, v36, v40
v_sub_f32 v28, v28, v40
v_exp_f32 v36, v36
v_exp_f32 v28, v28
v_mul_f32 v36, v36, v37
s_nop 1
v_add_f32_dpp v36, v36, v36 quad_perm:[1,0,3,2] row_mask:0xf bank_mask:0xf
s_nop 1
v_add_f32_dpp v36, v36, v36 quad_perm:[2,3,0,1] row_mask:0xf bank_mask:0xf
s_nop 1
v_add_f32_dpp v36, v36, v36 row_half_mirror row_mask:0xf bank_mask:0xf
v_rcp_f32 v36, v36
s_nop 0
v_mul_f32 v17, v28, v36
v_and_b32 v1, 4, v0
v_cmp_ne_u32 vcc, 0, v1
v_mov_b32 v16, v17
s_nop 1
v_permlane32_swap_b32 v17, v16
v_cndmask_b32 v17, v17, v16, vcc
s_branch L_po14
L_pad14:
s_setpc_b64 s[64:65]
L_po14:
s_mov_b32 s63, 8000000
s_setprio 3
s_waitcnt vmcnt(0) lgkmcnt(0)
s_barrier
ds_read_b128 v[192:195], v4 offset:0
ds_read_b128 v[196:199], v4 offset:1024
ds_read_b128 v[200:203], v4 offset:2048
ds_read_b128 v[204:207], v4 offset:3072
s_waitcnt lgkmcnt(2)
v_add_f32 v32, v192, v196
v_add_f32 v33, v193, v197
v_add_f32 v34, v194, v198
v_add_f32 v35, v195, v199
s_waitcnt lgkmcnt(1)
v_add_f32 v32, v32, v200
v_add_f32 v33, v33, v201
v_add_f32 v34, v34, v202
v_add_f32 v35, v35, v203
s_waitcnt lgkmcnt(0)
v_add_f32 v32, v32, v204
v_add_f32 v33, v33, v205
v_add_f32 v34, v34, v206
v_add_f32 v35, v35, v207
v_mul_f32 v32, v17, v32
v_mul_f32 v33, v17, v33
v_mul_f32 v34, v17, v34
v_mul_f32 v35, v17, v35
v_bfi_b32 v36, 63, v56, v32
v_bfi_b32 v37, 63, v56, v33
v_bfi_b32 v38, 63, v56, v34
v_bfi_b32 v39, 63, v56, v35
buffer_store_dwordx4 v[36:39], v14, s[40:43], 0 offen sc1
s_cmp_ge_u32 s34, 5
s_cbranch_scc1 L_fin
s_barrier
ds_read_b128 v[192:195], v4 offset:0
ds_read_b128 v[196:199], v4 offset:1024
ds_read_b128 v[200:203], v4 offset:2048
ds_read_b128 v[204:207], v4 offset:3072
s_waitcnt lgkmcnt(2)
v_add_f32 v32, v192, v196
v_add_f32 v33, v193, v197
v_add_f32 v34, v194, v198
v_add_f32 v35, v195, v199
s_waitcnt lgkmcnt(1)
v_add_f32 v32, v32, v200
v_add_f32 v33, v33, v201
v_add_f32 v34, v34, v202
v_add_f32 v35, v35, v203
s_waitcnt lgkmcnt(0)
v_add_f32 v32, v32, v204
v_add_f32 v33, v33, v205
v_add_f32 v34, v34, v206
v_add_f32 v35, v35, v207
v_bfi_b32 v32, 63, v57, v32
v_bfi_b32 v33, 63, v57, v33
v_bfi_b32 v34, 63, v57, v34
v_bfi_b32 v35, 63, v57, v35
buffer_store_dwordx4 v[32:35], v15, s[40:43], 0 offen
buffer_store_dwordx4 v[32:35], v53, s[40:43], 0 offen sc1
buffer_load_dwordx4 v[64:67], v44, s[8:11], 0 offen sc1
L_gy:
buffer_load_dwordx4 v[68:71], v44, s[8:11], 0 offen sc1
s_waitcnt vmcnt(1)
v_xor_b32 v40, v64, v48
v_xor_b32 v41, v65, v48
v_xor_b32 v42, v66, v48
v_xor_b32 v43, v67, v48
v_or_b32 v1, v40, v41
v_or3_b32 v1, v42, v43, v1
v_and_b32 v1, 63, v1
v_cmp_ne_u32 vcc, 0, v1
v_permlane32_swap_b32 v40, v41
v_permlane32_swap_b32 v42, v43
v_add_f32 v40, v40, v41
v_add_f32 v42, v42, v43
s_cbranch_vccz L_gy_ok
buffer_load_dwordx4 v[64:67], v44, s[8:11], 0 offen sc1
s_waitcnt vmcnt(1)
v_xor_b32 v40, v68, v48
v_xor_b32 v41, v69, v48
v_xor_b32 v42, v70, v48
v_xor_b32 v43, v71, v48
v_or_b32 v1, v40, v41
v_or3_b32 v1, v42, v43, v1
v_and_b32 v1, 63, v1
v_cmp_ne_u32 vcc, 0, v1
v_permlane32_swap_b32 v40, v41
v_permlane32_swap_b32 v42, v43
v_add_f32 v40, v40, v41
v_add_f32 v42, v42, v43
s_cbranch_vccz L_gy_ok
s_sub_u32 s63, s63, 1
s_cbranch_scc0 L_gy
L_gy_ok:
s_nop 0
v_permlane16_swap_b32 v40, v42
v_add_f32 v40, v40, v42
s_nop 1
v_add_f32_dpp v40, v40, v40 row_ror:8 row_mask:0xf bank_mask:0xf
s_nop 1
v_add_f32_dpp v40, v40, v40 row_ror:4 row_mask:0xf bank_mask:0xf
s_nop 1
v_add_f32_dpp v40, v40, v40 quad_perm:[2,3,0,1] row_mask:0xf bank_mask:0xf
v_cvt_pk_bf16_f32 v40, v40, v40
buffer_store_short v40, v20, s[20:23], 0 offen
L_fin:
s_endpgm
L_balance:
s_getreg_b32 s38, hwreg(HW_REG_XCC_ID, 0, 3)
s_bitcmp0_b32 s38, 0
s_cselect_b32 s37, 10, -10
s_mul_i32 s38, s38, 4352
s_mov_b32 s26, 128
s_mov_b32 s27, 0x20000
s_mov_b32 s22, 34816
s_mov_b32 s23, 0x20000
s_mov_b32 s50, 4
s_mov_b32 s51, 0x20000
s_lshl_b32 s30, s33, 2
v_lshl_add_u32 v16, v0, 24, s30
v_mul_u32_u24 v13, 4352, v0
s_add_u32 s28, s38, 0x4000000
v_mov_b32 v54, 0
v_mov_b32 v55, 0
v_mov_b32 v15, -120
s_mov_b32 s36, 0
s_waitcnt lgkmcnt(0)
s_add_u32 s24, s18, s28
s_addc_u32 s25, s19, 0
s_add_u32 s20, s18, 0x4010000
s_addc_u32 s21, s19, 0
s_add_u32 s48, s20, s38
s_addc_u32 s49, s21, 0
buffer_store_dword v52, v5, s[24:27], 0 offen
s_mov_b32 s4, 0
s_mov_b32 s5, 0
s_mov_b32 s63, 20000000
s_cmp_lg_u32 s33, 31
s_cbranch_scc1 L_nr0
buffer_load_dword v55, v13, s[20:23], 0 offen sc1
L_nr0:
s_cmp_lt_u32 s39, 4
s_cbranch_scc1 L_pb
s_barrier
L_pb:
s_call_b64 s[64:65], L_pad0
s_call_b64 s[64:65], L_pad1
s_call_b64 s[64:65], L_pad2
s_call_b64 s[64:65], L_pad3
s_call_b64 s[64:65], L_pad4
s_call_b64 s[64:65], L_pad5
s_waitcnt vmcnt(0)
v_mov_b32 v14, v55
s_barrier
L_fb1:
s_sleep 1
ds_read_b32 v48, v9
s_waitcnt lgkmcnt(0)
v_add_u32_dpp v49, v48, v48 quad_perm:[1,0,3,2] row_mask:0xf bank_mask:0xf
v_cmp_gt_u32 vcc, 0x7c, v48
s_sub_u32 s63, s63, 1
v_add_u32_dpp v49, v49, v49 quad_perm:[2,3,0,1] row_mask:0xf bank_mask:0xf
s_cbranch_scc1 L_fbx
s_cbranch_vccz L_fbx
v_add_u32 v49, 2, v49
v_lshrrev_b32 v49, 2, v49
s_nop 0
v_readfirstlane_b32 s6, v49
v_or_b32 v49, s36, v49
s_cmp_eq_u32 s6, s4
s_cbranch_scc1 L_fb1
s_mov_b32 s4, s6
s_cmp_lt_u32 s4, 10
s_cbranch_scc1 L_fb1
buffer_store_dword v49, v16, s[24:27], 0 offen
s_bitcmp1_b32 s4, 0
s_cbranch_scc1 L_fb1
s_waitcnt vmcnt(1)
v_readlane_b32 s7, v52, 31
v_and_b32 v52, 0xffff, v52
v_cmp_ne_u32 vcc, 0, v52
v_subrev_u32 v51, s5, v52
v_sub_u32 v53, s5, v54
v_cndmask_b32 v51, 0, v51, vcc
v_mov_b32 v47, v55
buffer_load_dword v52, v5, s[24:27], 0 offen sc1
s_cmp_lg_u32 s33, 31
s_cbranch_scc1 L_nr1
buffer_load_dword v55, v13, s[20:23], 0 offen sc1
L_nr1:
s_lshl_b32 s29, s5, 5
s_ashr_i32 s7, s7, 16
v_mov_b32 v54, v48
s_mov_b32 s5, s4
v_add_u32_dpp v51, v51, v51 quad_perm:[1,0,3,2] row_mask:0xf bank_mask:0xf
s_nop 1
v_add_u32_dpp v51, v51, v51 quad_perm:[2,3,0,1] row_mask:0xf bank_mask:0xf
s_nop 1
v_add_u32_dpp v51, v51, v51 row_half_mirror row_mask:0xf bank_mask:0xf
s_nop 1
v_add_u32_dpp v51, v51, v51 row_mirror row_mask:0xf bank_mask:0xf
s_nop 1
v_mov_b32 v50, v51
s_nop 1
v_permlane16_swap_b32 v51, v50
v_add_u32 v51, v51, v50
s_nop 0
v_readfirstlane_b32 s6, v51
s_nop 1
s_add_u32 s29, s29, s6
s_add_u32 s6, s6, s7
s_add_u32 s6, s6, s37
v_lshl_add_u32 v53, v53, 5, s6
v_cmp_lt_i32 vcc, 16, v53
s_nop 1
v_cndmask_b32 v50, 0, v19, vcc
v_cmp_lt_i32 vcc, 80, v53
s_nop 1
v_cndmask_b32 v50, v50, 3, vcc
ds_write_b32 v9, v50 offset:16
s_cmp_lg_u32 s33, 31
s_cbranch_scc1 L_fb1
v_cmp_ne_u32 vcc, v47, v14
v_subrev_u32 v50, s29, v47
v_mov_b32 v14, v47
v_max_i32 v50, -248, v50
v_min_i32 v50, 8, v50
v_cndmask_b32 v15, v15, v50, vcc
s_nop 1
v_add_u32_dpp v50, v15, v15 quad_perm:[1,0,3,2] row_mask:0xf bank_mask:0xf
s_nop 1
v_add_u32_dpp v50, v50, v50 quad_perm:[2,3,0,1] row_mask:0xf bank_mask:0xf
s_nop 1
v_add_u32_dpp v50, v50, v50 row_half_mirror row_mask:0xf bank_mask:0xf
v_ashrrev_i32 v50, 3, v50
v_add_u32 v50, 120, v50
v_ashrrev_i32 v50, 1, v50
v_min_i32 v50, 16, v50
v_lshlrev_b32 v50, 16, v50
s_nop 0
v_readfirstlane_b32 s36, v50
s_add_u32 s6, s4, 12
s_and_b32 s6, s6, 15
s_cbranch_scc1 L_fb1
s_cmp_lt_u32 s4, 20
s_cbranch_scc1 L_fb1
v_mov_b32 v51, s29
buffer_store_dword v51, v5, s[48:51], 0 offen sc1
s_branch L_fb1
L_fbx:
s_endpgm
.section .rodata,"a"
.p2align 6
.amdhsa_kernel standalone__mha_block_cached__decode_kernel
  .amdhsa_next_free_vgpr 256
  .amdhsa_next_free_sgpr 96
  .amdhsa_accum_offset 256
  .amdhsa_group_segment_fixed_size 0
  .amdhsa_kernarg_size 64
  .amdhsa_user_sgpr_count 2
  .amdhsa_user_sgpr_kernarg_segment_ptr 1
  .amdhsa_system_sgpr_workgroup_id_x 1
.end_amdhsa_kernel
```
